```python
import torch

def _softmax(x, axis=-1):
    return torch.softmax(x, dim=axis)
def _gelu(x):
    return torch.nn.functional.gelu(x, approximate="tanh")
def _silu(x):
    return torch.nn.functional.silu(x)
def _sigmoid(x):
    return torch.sigmoid(x)
def _layernorm(x, axis=-1, eps=1e-5):
    m = x.mean(dim=axis, keepdim=True)
    v = x.var(dim=axis, keepdim=True, unbiased=False)
    return (x - m) / torch.sqrt(v + eps)
def _scatter_add(tgt, idx, src, axis=0):
    return tgt.clone().index_add_(axis, idx, src)
def _segment_sum(src, seg, n):
    out = torch.zeros((n,) + src.shape[1:], dtype=src.dtype)
    return out.index_add_(0, seg, src)
def _pad(x, pw):
    flat = tuple(v for pair in reversed(pw) for v in pair)
    return torch.nn.functional.pad(x, flat)

kernel_name = 'sequential_preLN__sliding_local_dilated__dense_activation_relu__prompt'

def setup_inputs():

    _w = (lambda a: (lambda t: t.to(torch.bfloat16) if t.is_floating_point() else t)(torch.as_tensor(a)))
    def _A_setup():
        B, S, D = 1, 2048, 448
        return {
            "x": _w((lambda *s: torch.randn(*s, dtype=torch.bfloat16) * 0.05)(B, S, D)),
            "wqkv": _w((lambda *s: torch.randn(*s, dtype=torch.bfloat16) * 0.05)(D, 3 * D)),
            "wo": _w((lambda *s: torch.randn(*s, dtype=torch.bfloat16) * 0.05)(D, D)),
        }
    _A_in = _A_setup()

    def _B_setup():
        B, S, D, Dff = 1, 2048, 448, 1792
        return {
            "x": _w((lambda *s: torch.randn(*s, dtype=torch.bfloat16) * 0.05)(B, S, D)),
            "w1": _w((lambda *s: torch.randn(*s, dtype=torch.bfloat16) * 0.05)(D, Dff)),
            "w2": _w((lambda *s: torch.randn(*s, dtype=torch.bfloat16) * 0.05)(Dff, D)),
        }
    _B_in = _B_setup()

    return {
        "A_x": _A_in["x"],
        "A_wqkv": _A_in["wqkv"],
        "A_wo": _A_in["wo"],
        "B_x": _B_in["x"],
        "B_w1": _B_in["w1"],
        "B_w2": _B_in["w2"],
    }

def reference(A_x, A_wqkv, A_wo, B_x, B_w1, B_w2):
    def _A_ref(x, wqkv, wo):
        B, S, D = x.shape
        H = 16; Dh = D // H
        W, dil = 8, 2
        qkv = (lambda x, *d: x.permute(*d))((x @ wqkv).reshape(B, S, 3, H, Dh), 2, 0, 3, 1, 4)
        q, k, v = qkv[0], qkv[1], qkv[2]
        scale = Dh ** -0.5
        pos = torch.arange(S)
        off = torch.arange(W) * dil
        idx = pos[:, None] - off[None, :]
        mask = idx >= 0
        idx_c = torch.where(mask, idx, 0).reshape(-1)
        kg = k[:, :, idx_c, :].reshape(B, H, S, W, Dh)
        vg = v[:, :, idx_c, :].reshape(B, H, S, W, Dh)
        logits = torch.einsum("bhsd,bhswd->bhsw", q, kg) * scale
        logits = torch.where(mask[None, None, :, :], logits, -1e9)
        attn = _softmax(logits, axis=-1)
        o = torch.einsum("bhsw,bhswd->bhsd", attn, vg)
        return (lambda x, *d: x.permute(*d))(o, 0, 2, 1, 3).reshape(B, S, D) @ wo

    def _B_ref(x, w1, w2):
        h = torch.einsum("bsd,df->bsf", x, w1)
        zero = torch.zeros_like(h)
        h = torch.maximum(h, zero)
        return torch.einsum("bsf,fd->bsd", h, w2)

    x = A_x
    h = x + _A_ref(_layernorm(x, axis=-1), A_wqkv, A_wo)
    h2 = h + _B_ref(_layernorm(h, axis=-1), B_w1, B_w2)
    return h2
```

```asm
; @launch grid=(256,1,1) block=(256,1,1) lds=163840
.amdgcn_target "amdgcn-amd-amdhsa--gfx950"
.text
.globl sequential_preLN__sliding_local_dilated__dense_activation_relu__prompt_kernel
.p2align 8
.type sequential_preLN__sliding_local_dilated__dense_activation_relu__prompt_kernel,@function
sequential_preLN__sliding_local_dilated__dense_activation_relu__prompt_kernel:
    s_cmp_ge_u32 s2, 256
    s_cbranch_scc1 K_done
    s_load_dwordx4 s[44:47], s[0:1], 0
    s_load_dwordx2 s[60:61], s[0:1], 64
    s_load_dwordx4 s[56:59], s[0:1], 48
    s_load_dwordx2 s[48:49], s[0:1], 16
    s_load_dwordx4 s[52:55], s[0:1], 32
    v_lshrrev_b32 v2, 6, v0
    v_and_b32 v1, 63, v0
    v_readfirstlane_b32 s3, v2
    s_lshr_b32 s38, s2, 3
    s_cmp_ge_u32 s38, 4
    s_cbranch_scc1 IC_1
    s_nop 0
    s_cmp_lg_u32 s3, 3
    s_cbranch_scc1 IC_1
    s_getpc_b64 s[36:37]
K_pc:
    s_lshl_b32 s38, s38, 13
    v_lshlrev_b32 v13, 7, v1
    v_add_u32 v13, s38, v13
    v_min_u32 v13, K_done-K_pc, v13
    global_load_dword v254, v13, s[36:37]
IC_1:
    s_and_b32 s36, s2, 7
    s_lshr_b32 s37, s2, 3
    s_and_b32 s34, s36, 1
    s_lshr_b32 s36, s36, 1
    s_lshl_b32 s36, s36, 2
    s_lshr_b32 s38, s37, 3
    s_add_u32 s32, s36, s38
    s_and_b32 s35, s37, 7
    s_lshl_b32 s36, s34, 3
    s_add_u32 s39, s36, s35
    s_mul_i32 s36, s34, 7
    s_add_u32 s33, s36, s35
    s_lshl_b32 s36, s32, 7
    s_sub_u32 s36, s36, 16
    s_lshl_b32 s37, s3, 3
    s_add_u32 s36, s36, s37
    v_lshrrev_b32 v13, 3, v1
    v_add_u32 v13, s36, v13
    s_and_b32 s37, s3, 1
    s_lshl_b32 s37, s37, 2
    v_lshrrev_b32 v14, 4, v1
    v_add_u32 v14, s37, v14
    v_and_b32 v15, 7, v1
    v_xor_b32 v14, v14, v15
    v_lshlrev_b32 v14, 4, v14
    s_movk_i32 s38, 896
    v_max_i32 v15, 0, v13
    v_mad_u32_u24 v2, v15, s38, v14
    v_add_u32 v13, 32, v13
    v_mad_u32_u24 v3, v13, s38, v14
    s_lshl_b32 s36, s32, 7
    s_add_u32 s36, s36, 112
    s_lshl_b32 s37, s3, 2
    s_add_u32 s36, s36, s37
    v_lshrrev_b32 v13, 3, v1
    v_add_u32 v13, s36, v13
    s_lshl_b32 s37, s3, 1
    v_lshrrev_b32 v14, 4, v1
    v_add_u32 v14, s37, v14
    v_and_b32 v14, 7, v14
    v_and_b32 v15, 7, v1
    v_xor_b32 v14, v14, v15
    v_lshlrev_b32 v14, 4, v14
    v_mad_u32_u24 v4, v13, s38, v14
    s_lshl_b32 s36, s3, 4
    v_lshrrev_b32 v13, 2, v1
    v_add_u32 v13, s36, v13
    s_movk_i32 s38, 2688
    v_lshrrev_b32 v14, 5, v1
    v_lshlrev_b32 v14, 1, v14
    v_and_b32 v15, 3, v1
    v_xor_b32 v14, v14, v15
    v_lshlrev_b32 v14, 4, v14
    v_min_u32 v14, 40, v14
    s_mul_i32 s36, s39, 56
    v_mad_u32_u24 v13, v13, s38, v14
    v_add_u32 v5, s36, v13
    s_lshl_b32 s62, s3, 10
    s_lshl_b32 s63, s3, 9
    s_waitcnt lgkmcnt(0)
    s_mov_b32 s8, s44
    s_and_b32 s9, s45, 0xffff
    s_mov_b32 s10, 1835008
    s_mov_b32 s11, 0x20000
    s_mov_b32 s12, s46
    s_and_b32 s13, s47, 0xffff
    s_mov_b32 s14, 1204224
    s_mov_b32 s15, 0x20000
    s_and_b32 s36, s32, 3
    s_mul_i32 s36, s36, 1
    s_lshl_b32 s44, s36, 7
    s_mul_i32 s45, s36, 172032
    s_add_u32 m0, s62, 18432
    s_mov_b32 s46, s45
    buffer_load_dwordx4 v5, s[12:15], s46 offen lds
    s_add_u32 m0, s62, 0
    s_mov_b32 s46, s44
    buffer_load_dwordx4 v2, s[8:11], s46 offen lds
    s_mov_b32 s16, s60
    s_and_b32 s17, s61, 0xffff
    s_mov_b32 s18, 16777216
    s_mov_b32 s19, 0x20000
    s_or_b32 s36, s39, s3
    s_cmp_lg_u32 s36, 0
    s_cbranch_scc1 LZ_2
    v_lshlrev_b32 v13, 4, v1
    v_mov_b32 v16, 0
    v_mov_b32 v17, 0
    v_mov_b32 v18, 0
    v_mov_b32 v19, 0
    s_lshl_b32 s36, s32, 9
    s_add_u32 s36, s36, 8323072
    s_mov_b64 exec, 0xffff
    buffer_store_dwordx4 v[16:19], v13, s[16:19], s36 offen sc1
    s_mov_b64 exec, -1
LZ_2:
    s_add_u32 m0, s62, 22528
    s_add_u32 s46, s45, 896
    buffer_load_dwordx4 v5, s[12:15], s46 offen lds
    s_mov_b32 s20, s56
    s_and_b32 s21, s57, 0xffff
    s_mov_b32 s22, 1835008
    s_mov_b32 s23, 0x20000
    s_mov_b32 s28, s58
    s_and_b32 s29, s59, 0xffff
    s_mov_b32 s30, 256
    s_mov_b32 s31, 0x20000
    s_mov_b32 s76, s54
    s_and_b32 s77, s55, 0xffff
    s_mov_b32 s78, 1605632
    s_add_u32 m0, s62, 4096
    s_mov_b32 s46, s44
    buffer_load_dwordx4 v3, s[8:11], s46 offen lds
    s_mov_b32 s79, 0x20000
    s_mov_b32 s24, s52
    s_and_b32 s25, s53, 0xffff
    s_mov_b32 s26, 1605632
    s_mov_b32 s27, 0x20000
    s_mov_b32 s84, s52
    s_and_b32 s85, s53, 0xffff
    s_mov_b32 s86, 1605632
    s_mov_b32 s87, 0x20000
    s_mov_b32 s4, s48
    s_and_b32 s5, s49, 0xffff
    s_add_u32 m0, s62, 26624
    s_add_u32 s46, s45, 1792
    buffer_load_dwordx4 v5, s[12:15], s46 offen lds
    s_mov_b32 s6, 401408
    s_mov_b32 s7, 0x20000
    v_lshlrev_b32 v10, 4, v1
    v_and_b32 v13, 15, v1
    s_lshl_b32 s36, s3, 5
    v_add_u32 v14, s36, v13
    v_lshlrev_b32 v14, 7, v14
    v_lshrrev_b32 v13, 1, v13
    v_lshrrev_b32 v15, 4, v1
    v_xor_b32 v13, v13, v15
    v_lshl_add_u32 v6, v13, 4, v14
    s_add_u32 m0, s62, 8192
    s_add_u32 s46, s44, 28672
    buffer_load_dwordx4 v3, s[8:11], s46 offen lds
    v_xor_b32 v13, 4, v13
    v_lshl_add_u32 v7, v13, 4, v14
    v_lshrrev_b32 v13, 4, v1
    v_lshlrev_b32 v14, 3, v13
    v_bfe_u32 v15, v1, 2, 2
    v_add_u32 v14, v14, v15
    v_lshlrev_b32 v14, 6, v14
    v_add_u32 v14, 18432, v14
    v_and_b32 v13, 1, v13
    v_lshlrev_b32 v13, 1, v13
    v_bfe_u32 v15, v1, 1, 1
    s_add_u32 m0, s62, 12288
    s_add_u32 s46, s44, 57344
    buffer_load_dwordx4 v3, s[8:11], s46 offen lds
    v_add_u32 v13, v13, v15
    v_lshl_add_u32 v8, v13, 4, v14
    v_xor_b32 v13, 2, v13
    v_lshl_add_u32 v9, v13, 4, v14
    v_and_b32 v13, 1, v1
    v_lshl_add_u32 v8, v13, 3, v8
    v_xor_b32 v13, v13, v15
    v_lshl_add_u32 v9, v13, 3, v9
    v_mov_b32 v16, 0x3f803f80
    v_mov_b32 v17, 0x3f803f80
    v_mov_b32 v18, 0x3f803f80
    s_add_u32 m0, s63, 16384
    s_mov_b32 s46, s44
    s_mov_b32 exec_hi, 0
    buffer_load_dwordx4 v4, s[8:11], s46 offen lds
    s_mov_b32 exec_hi, -1
    v_mov_b32 v19, 0x3f803f80
    v_and_b32 v13, 15, v1
    v_lshrrev_b32 v15, 2, v13
    v_lshl_add_u32 v11, v15, 4, v13
    v_lshlrev_b32 v11, 2, v11
    v_cmp_eq_u32 s[74:75], 0, v13
    v_cmp_lt_u32 s[80:81], 11, v13
    v_lshrrev_b32 v14, 4, v1
    v_lshlrev_b32 v12, 4, v14
    v_cmp_eq_u32 s[64:65], 3, v14
    v_and_b32 v15, 3, v1
    s_add_u32 s44, s44, 128
    s_add_u32 s45, s45, 172032
    s_cmp_eq_u32 s44, 896
    s_cselect_b32 s44, 0, s44
    s_cselect_b32 s45, 0, s45
    s_add_u32 m0, s62, 49152
    s_mov_b32 s46, s45
    buffer_load_dwordx4 v5, s[12:15], s46 offen lds
    v_cmp_eq_u32 s[66:67], 1, v15
    v_cmp_eq_u32 s[68:69], 2, v15
    v_cmp_eq_u32 s[70:71], 3, v15
    v_lshlrev_b32 v14, 2, v14
    v_sub_u32 v13, v13, v14
    v_mov_b32 v15, 0xf149f2ca
    v_mov_b32 v248, 0
    v_subrev_u32 v14, 0, v13
    v_and_b32 v249, 0x80000001, v14
    v_cmp_eq_u32 vcc, 0, v249
    s_nop 1
    v_cndmask_b32 v240, v15, v248, vcc
    s_add_u32 m0, s62, 30720
    s_mov_b32 s46, s44
    buffer_load_dwordx4 v2, s[8:11], s46 offen lds
    v_add_u32 v14, 1, v14
    v_and_b32 v249, 0x80000001, v14
    v_cmp_eq_u32 vcc, 0x80000001, v249
    s_nop 1
    v_cndmask_b32 v236, v15, v248, vcc
    v_subrev_u32 v14, 1, v13
    v_and_b32 v249, 0x80000001, v14
    v_cmp_eq_u32 vcc, 0, v249
    s_nop 1
    v_cndmask_b32 v241, v15, v248, vcc
    v_add_u32 v14, 1, v14
    v_and_b32 v249, 0x80000001, v14
    v_cmp_eq_u32 vcc, 0x80000001, v249
    s_add_u32 m0, s62, 53248
    s_add_u32 s46, s45, 896
    buffer_load_dwordx4 v5, s[12:15], s46 offen lds
    v_cndmask_b32 v237, v15, v248, vcc
    v_subrev_u32 v14, 2, v13
    v_and_b32 v249, 0x80000001, v14
    v_cmp_eq_u32 vcc, 0, v249
    s_nop 1
    v_cndmask_b32 v242, v15, v248, vcc
    v_add_u32 v14, 1, v14
    v_and_b32 v249, 0x80000001, v14
    v_cmp_eq_u32 vcc, 0x80000001, v249
    s_nop 1
    v_cndmask_b32 v238, v15, v248, vcc
    v_subrev_u32 v14, 3, v13
    v_and_b32 v249, 0x80000001, v14
    s_add_u32 m0, s62, 34816
    s_mov_b32 s46, s44
    buffer_load_dwordx4 v3, s[8:11], s46 offen lds
    v_cmp_eq_u32 vcc, 0, v249
    s_nop 1
    v_cndmask_b32 v243, v15, v248, vcc
    v_add_u32 v14, 1, v14
    v_and_b32 v249, 0x80000001, v14
    v_cmp_eq_u32 vcc, 0x80000001, v249
    s_nop 1
    v_cndmask_b32 v239, v15, v248, vcc
    s_or_b32 s36, s32, s3
    s_cmp_eq_u32 s36, 0
    s_cselect_b64 s[72:73], -1, 0
    v_cndmask_b32 v244, v236, v15, s[72:73]
    v_cndmask_b32 v245, v237, v15, s[72:73]
    s_add_u32 m0, s62, 57344
    s_add_u32 s46, s45, 1792
    buffer_load_dwordx4 v5, s[12:15], s46 offen lds
    v_cndmask_b32 v246, v238, v15, s[72:73]
    v_cndmask_b32 v247, v239, v15, s[72:73]
    v_bfe_u32 v13, v1, 1, 2
    v_bfe_u32 v14, v1, 4, 2
    v_xor_b32 v13, v13, v14
    v_lshlrev_b32 v13, 5, v13
    v_and_b32 v14, 1, v1
    v_lshl_add_u32 v13, v14, 4, v13
    v_lshrrev_b32 v14, 3, v1
    s_movk_i32 s36, 896
    v_mad_u32_u24 v252, v14, s36, v13
    s_add_u32 m0, s62, 38912
    s_add_u32 s46, s44, 28672
    buffer_load_dwordx4 v3, s[8:11], s46 offen lds
    s_and_b32 s36, s3, 1
    v_lshrrev_b32 v14, 4, v1
    v_lshl_add_u32 v15, v14, 1, s36
    v_bfe_u32 v13, v1, 1, 3
    v_xor_b32 v13, v13, v15
    v_lshlrev_b32 v13, 5, v13
    v_and_b32 v15, 1, v1
    v_lshl_add_u32 v13, v15, 4, v13
    s_movk_i32 s36, 3584
    v_mad_u32_u24 v253, v14, s36, v13
    v_lshrrev_b32 v13, 2, v1
    s_add_u32 m0, s62, 43008
    s_add_u32 s46, s44, 57344
    buffer_load_dwordx4 v3, s[8:11], s46 offen lds
    v_lshrrev_b32 v14, 1, v13
    v_and_b32 v14, 3, v14
    v_and_b32 v15, 3, v1
    v_lshlrev_b32 v15, 3, v15
    v_lshl_add_u32 v248, v13, 7, v15
    v_lshl_add_u32 v224, v14, 5, v248
    v_xor_b32 v225, 32, v224
    v_xor_b32 v226, 64, v224
    v_xor_b32 v227, 96, v224
    s_add_u32 m0, s63, 47104
    s_mov_b32 s46, s44
    s_mov_b32 exec_hi, 0
    buffer_load_dwordx4 v4, s[8:11], s46 offen lds
    s_mov_b32 exec_hi, -1
    s_or_b32 s36, s39, s3
    s_cmp_lg_u32 s36, 0
    s_cbranch_scc1 LH_3
    s_waitcnt vmcnt(14)
    s_lshl_b32 s36, s32, 2
    v_mov_b32 v13, s36
    v_mov_b32 v14, 1
    s_mov_b64 exec, 1
    buffer_store_dword v14, v13, s[28:31], 0 offen sc1
    s_mov_b64 exec, -1
LH_3:
    s_waitcnt vmcnt(8)
    s_barrier
    ds_read_b128 v[20:23], v6 offset:0
    ds_read_b128 v[24:27], v6 offset:2048
    ds_read_b128 v[28:31], v6 offset:4096
    ds_read_b64_tr_b16 v[44:45], v8 offset:0
    ds_read_b64_tr_b16 v[46:47], v8 offset:256
    ds_read_b64_tr_b16 v[48:49], v9 offset:0
    ds_read_b64_tr_b16 v[50:51], v9 offset:256
    ds_read_b64_tr_b16 v[52:53], v8 offset:4096
    ds_read_b64_tr_b16 v[54:55], v8 offset:4352
    ds_read_b64_tr_b16 v[56:57], v9 offset:4096
    ds_read_b64_tr_b16 v[58:59], v9 offset:4352
    ds_read_b64_tr_b16 v[60:61], v8 offset:8192
    ds_read_b64_tr_b16 v[62:63], v8 offset:8448
    ds_read_b64_tr_b16 v[64:65], v9 offset:8192
    ds_read_b64_tr_b16 v[66:67], v9 offset:8448
    s_waitcnt lgkmcnt(0)
    v_mfma_f32_16x16x32_bf16 v[92:95], v[44:47], v[24:27], 0
    v_cndmask_b32 v20, v20, v16, s[74:75]
    v_cndmask_b32 v21, v21, v16, s[74:75]
    s_add_u32 s44, s44, 128
    s_add_u32 s45, s45, 172032
    s_cmp_eq_u32 s44, 896
    s_cselect_b32 s44, 0, s44
    s_cselect_b32 s45, 0, s45
    s_add_u32 m0, s62, 79872
    s_mov_b32 s46, s45
    buffer_load_dwordx4 v5, s[12:15], s46 offen lds
    ds_read_b128 v[32:35], v7 offset:0
    v_mfma_f32_16x16x32_bf16 v[100:103], v[44:47], v[28:31], 0
    v_cndmask_b32 v22, v22, v16, s[74:75]
    v_cndmask_b32 v23, v23, v16, s[74:75]
    ds_read_b128 v[36:39], v7 offset:2048
    s_add_u32 m0, s62, 61440
    s_mov_b32 s46, s44
    buffer_load_dwordx4 v2, s[8:11], s46 offen lds
    v_mfma_f32_16x16x32_bf16 v[96:99], v[48:51], v[24:27], 0
    v_cndmask_b32 v56, v56, v16, s[80:81]
    v_cndmask_b32 v57, v57, v16, s[80:81]
    ds_read_b128 v[40:43], v7 offset:4096
    v_mfma_f32_16x16x32_bf16 v[104:107], v[48:51], v[28:31], 0
    s_add_u32 m0, s62, 83968
    s_add_u32 s46, s45, 896
    buffer_load_dwordx4 v5, s[12:15], s46 offen lds
    v_cndmask_b32 v58, v58, v16, s[80:81]
    v_cndmask_b32 v59, v59, v16, s[80:81]
    ds_read_b64_tr_b16 v[68:69], v8 offset:2048
    v_mfma_f32_16x16x32_bf16 v[156:159], v[44:47], v[16:19], 0
    ds_read_b64_tr_b16 v[70:71], v8 offset:2304
    s_add_u32 m0, s62, 65536
    s_mov_b32 s46, s44
    buffer_load_dwordx4 v3, s[8:11], s46 offen lds
    v_mfma_f32_16x16x32_bf16 v[160:163], v[48:51], v[16:19], 0
    ds_read_b64_tr_b16 v[72:73], v9 offset:2048
    v_mfma_f32_16x16x32_bf16 v[108:111], v[52:55], v[20:23], 0
    ds_read_b64_tr_b16 v[74:75], v9 offset:2304
    v_mfma_f32_16x16x32_bf16 v[116:119], v[52:55], v[24:27], 0
    s_add_u32 m0, s62, 88064
    s_add_u32 s46, s45, 1792
    buffer_load_dwordx4 v5, s[12:15], s46 offen lds
    ds_read_b64_tr_b16 v[76:77], v8 offset:6144
    v_mfma_f32_16x16x32_bf16 v[124:127], v[52:55], v[28:31], 0
    ds_read_b64_tr_b16 v[78:79], v8 offset:6400
    v_mfma_f32_16x16x32_bf16 v[112:115], v[56:59], v[20:23], 0
    ds_read_b64_tr_b16 v[80:81], v9 offset:6144
    s_add_u32 m0, s62, 69632
    s_add_u32 s46, s44, 28672
    buffer_load_dwordx4 v3, s[8:11], s46 offen lds
    v_mfma_f32_16x16x32_bf16 v[120:123], v[56:59], v[24:27], 0
    ds_read_b64_tr_b16 v[82:83], v9 offset:6400
    v_mfma_f32_16x16x32_bf16 v[128:131], v[56:59], v[28:31], 0
    ds_read_b64_tr_b16 v[84:85], v8 offset:10240
    v_mfma_f32_16x16x32_bf16 v[132:135], v[20:23], v[60:63], 0
    s_add_u32 m0, s62, 73728
    s_add_u32 s46, s44, 57344
    buffer_load_dwordx4 v3, s[8:11], s46 offen lds
    ds_read_b64_tr_b16 v[86:87], v8 offset:10496
    v_mfma_f32_16x16x32_bf16 v[140:143], v[24:27], v[60:63], 0
    ds_read_b64_tr_b16 v[88:89], v9 offset:10240
    v_mfma_f32_16x16x32_bf16 v[148:151], v[28:31], v[60:63], 0
    ds_read_b64_tr_b16 v[90:91], v9 offset:10496
    s_add_u32 m0, s63, 77824
    s_mov_b32 s46, s44
    s_mov_b32 exec_hi, 0
    buffer_load_dwordx4 v4, s[8:11], s46 offen lds
    s_mov_b32 exec_hi, -1
    v_mfma_f32_16x16x32_bf16 v[136:139], v[20:23], v[64:67], 0
    v_mfma_f32_16x16x32_bf16 v[144:147], v[24:27], v[64:67], 0
    v_mfma_f32_16x16x32_bf16 v[152:155], v[28:31], v[64:67], 0
    v_mfma_f32_16x16x32_bf16 v[192:195], v[20:23], v[20:23], 0
    v_mfma_f32_16x16x32_bf16 v[196:199], v[24:27], v[24:27], 0
    v_mfma_f32_16x16x32_bf16 v[200:203], v[28:31], v[28:31], 0
    s_waitcnt lgkmcnt(0)
    v_mfma_f32_16x16x32_bf16 v[92:95], v[68:71], v[36:39], v[92:95]
    v_cndmask_b32 v32, v32, v16, s[74:75]
    v_cndmask_b32 v33, v33, v16, s[74:75]
    s_add_u32 s44, s44, 128
    s_add_u32 s45, s45, 172032
    s_cmp_eq_u32 s44, 896
    s_cselect_b32 s44, 0, s44
    s_cselect_b32 s45, 0, s45
    s_add_u32 m0, s62, 110592
    s_mov_b32 s46, s45
    buffer_load_dwordx4 v5, s[12:15], s46 offen lds
    v_mfma_f32_16x16x32_bf16 v[100:103], v[68:71], v[40:43], v[100:103]
    v_cndmask_b32 v34, v34, v16, s[74:75]
    v_cndmask_b32 v35, v35, v16, s[74:75]
    v_mfma_f32_16x16x32_bf16 v[96:99], v[72:75], v[36:39], v[96:99]
    s_add_u32 m0, s62, 92160
    s_mov_b32 s46, s44
    buffer_load_dwordx4 v2, s[8:11], s46 offen lds
    v_cndmask_b32 v80, v80, v16, s[80:81]
    v_cndmask_b32 v81, v81, v16, s[80:81]
    v_mfma_f32_16x16x32_bf16 v[104:107], v[72:75], v[40:43], v[104:107]
    v_cndmask_b32 v82, v82, v16, s[80:81]
    v_cndmask_b32 v83, v83, v16, s[80:81]
    s_waitcnt vmcnt(10)
    s_barrier
    v_add_u32 v6, 30720, v6
    v_add_u32 v7, 30720, v7
    v_add_u32 v8, 30720, v8
    v_add_u32 v9, 30720, v9
    v_mfma_f32_16x16x32_bf16 v[156:159], v[68:71], v[16:19], v[156:159]
    ds_read_b128 v[20:23], v6 offset:0
    v_mfma_f32_16x16x32_bf16 v[160:163], v[72:75], v[16:19], v[160:163]
    ds_read_b128 v[24:27], v6 offset:2048
    s_add_u32 m0, s62, 114688
    s_add_u32 s46, s45, 896
    buffer_load_dwordx4 v5, s[12:15], s46 offen lds
    v_mfma_f32_16x16x32_bf16 v[108:111], v[76:79], v[32:35], v[108:111]
    ds_read_b128 v[28:31], v6 offset:4096
    v_mfma_f32_16x16x32_bf16 v[116:119], v[76:79], v[36:39], v[116:119]
    ds_read_b64_tr_b16 v[44:45], v8 offset:0
    v_mfma_f32_16x16x32_bf16 v[124:127], v[76:79], v[40:43], v[124:127]
    s_add_u32 m0, s62, 96256
    s_mov_b32 s46, s44
    buffer_load_dwordx4 v3, s[8:11], s46 offen lds
    ds_read_b64_tr_b16 v[46:47], v8 offset:256
    v_mfma_f32_16x16x32_bf16 v[112:115], v[80:83], v[32:35], v[112:115]
    ds_read_b64_tr_b16 v[48:49], v9 offset:0
    v_mfma_f32_16x16x32_bf16 v[120:123], v[80:83], v[36:39], v[120:123]
    ds_read_b64_tr_b16 v[50:51], v9 offset:256
    s_add_u32 m0, s62, 118784
    s_add_u32 s46, s45, 1792
    buffer_load_dwordx4 v5, s[12:15], s46 offen lds
    v_mfma_f32_16x16x32_bf16 v[128:131], v[80:83], v[40:43], v[128:131]
    ds_read_b64_tr_b16 v[52:53], v8 offset:4096
    v_mfma_f32_16x16x32_bf16 v[132:135], v[32:35], v[84:87], v[132:135]
    ds_read_b64_tr_b16 v[54:55], v8 offset:4352
    v_mfma_f32_16x16x32_bf16 v[140:143], v[36:39], v[84:87], v[140:143]
    s_add_u32 m0, s62, 100352
    s_add_u32 s46, s44, 28672
    buffer_load_dwordx4 v3, s[8:11], s46 offen lds
    ds_read_b64_tr_b16 v[56:57], v9 offset:4096
    v_mfma_f32_16x16x32_bf16 v[148:151], v[40:43], v[84:87], v[148:151]
    ds_read_b64_tr_b16 v[58:59], v9 offset:4352
    v_mfma_f32_16x16x32_bf16 v[136:139], v[32:35], v[88:91], v[136:139]
    ds_read_b64_tr_b16 v[60:61], v8 offset:8192
    s_add_u32 m0, s62, 104448
    s_add_u32 s46, s44, 57344
    buffer_load_dwordx4 v3, s[8:11], s46 offen lds
    v_mfma_f32_16x16x32_bf16 v[144:147], v[36:39], v[88:91], v[144:147]
    ds_read_b64_tr_b16 v[62:63], v8 offset:8448
    v_mfma_f32_16x16x32_bf16 v[152:155], v[40:43], v[88:91], v[152:155]
    ds_read_b64_tr_b16 v[64:65], v9 offset:8192
    v_mfma_f32_16x16x32_bf16 v[192:195], v[32:35], v[32:35], v[192:195]
    s_add_u32 m0, s63, 108544
    s_mov_b32 s46, s44
    s_mov_b32 exec_hi, 0
    buffer_load_dwordx4 v4, s[8:11], s46 offen lds
    s_mov_b32 exec_hi, -1
    ds_read_b64_tr_b16 v[66:67], v9 offset:8448
    v_mfma_f32_16x16x32_bf16 v[196:199], v[36:39], v[36:39], v[196:199]
    v_mfma_f32_16x16x32_bf16 v[200:203], v[40:43], v[40:43], v[200:203]
    s_waitcnt lgkmcnt(0)
    v_mfma_f32_16x16x32_bf16 v[92:95], v[44:47], v[24:27], v[92:95]
    v_cndmask_b32 v20, v20, v16, s[74:75]
    v_cndmask_b32 v21, v21, v16, s[74:75]
    ds_read_b128 v[32:35], v7 offset:0
    v_mfma_f32_16x16x32_bf16 v[100:103], v[44:47], v[28:31], v[100:103]
    s_add_u32 s44, s44, 128
    s_add_u32 s45, s45, 172032
    s_cmp_eq_u32 s44, 896
    s_cselect_b32 s44, 0, s44
    s_cselect_b32 s45, 0, s45
    s_add_u32 m0, s62, 141312
    s_mov_b32 s46, s45
    buffer_load_dwordx4 v5, s[12:15], s46 offen lds
    v_cndmask_b32 v22, v22, v16, s[74:75]
    v_cndmask_b32 v23, v23, v16, s[74:75]
    ds_read_b128 v[36:39], v7 offset:2048
    v_mfma_f32_16x16x32_bf16 v[96:99], v[48:51], v[24:27], v[96:99]
    v_cndmask_b32 v56, v56, v16, s[80:81]
    v_cndmask_b32 v57, v57, v16, s[80:81]
    ds_read_b128 v[40:43], v7 offset:4096
    v_mfma_f32_16x16x32_bf16 v[104:107], v[48:51], v[28:31], v[104:107]
    v_cndmask_b32 v58, v58, v16, s[80:81]
    v_cndmask_b32 v59, v59, v16, s[80:81]
    s_add_u32 m0, s62, 122880
    s_mov_b32 s46, s44
    buffer_load_dwordx4 v2, s[8:11], s46 offen lds
    ds_read_b64_tr_b16 v[68:69], v8 offset:2048
    v_mfma_f32_16x16x32_bf16 v[156:159], v[44:47], v[16:19], v[156:159]
    ds_read_b64_tr_b16 v[70:71], v8 offset:2304
    v_mfma_f32_16x16x32_bf16 v[160:163], v[48:51], v[16:19], v[160:163]
    ds_read_b64_tr_b16 v[72:73], v9 offset:2048
    v_mfma_f32_16x16x32_bf16 v[108:111], v[52:55], v[20:23], v[108:111]
    ds_read_b64_tr_b16 v[74:75], v9 offset:2304
    v_mfma_f32_16x16x32_bf16 v[116:119], v[52:55], v[24:27], v[116:119]
    ds_read_b64_tr_b16 v[76:77], v8 offset:6144
    v_mfma_f32_16x16x32_bf16 v[124:127], v[52:55], v[28:31], v[124:127]
    s_add_u32 m0, s62, 145408
    s_add_u32 s46, s45, 896
    buffer_load_dwordx4 v5, s[12:15], s46 offen lds
    ds_read_b64_tr_b16 v[78:79], v8 offset:6400
    v_mfma_f32_16x16x32_bf16 v[112:115], v[56:59], v[20:23], v[112:115]
    ds_read_b64_tr_b16 v[80:81], v9 offset:6144
    v_mfma_f32_16x16x32_bf16 v[120:123], v[56:59], v[24:27], v[120:123]
    ds_read_b64_tr_b16 v[82:83], v9 offset:6400
    v_mfma_f32_16x16x32_bf16 v[128:131], v[56:59], v[28:31], v[128:131]
    ds_read_b64_tr_b16 v[84:85], v8 offset:10240
    v_mfma_f32_16x16x32_bf16 v[132:135], v[20:23], v[60:63], v[132:135]
    ds_read_b64_tr_b16 v[86:87], v8 offset:10496
    v_mfma_f32_16x16x32_bf16 v[140:143], v[24:27], v[60:63], v[140:143]
    s_add_u32 m0, s62, 126976
    s_mov_b32 s46, s44
    buffer_load_dwordx4 v3, s[8:11], s46 offen lds
    ds_read_b64_tr_b16 v[88:89], v9 offset:10240
    v_mfma_f32_16x16x32_bf16 v[148:151], v[28:31], v[60:63], v[148:151]
    ds_read_b64_tr_b16 v[90:91], v9 offset:10496
    v_mfma_f32_16x16x32_bf16 v[136:139], v[20:23], v[64:67], v[136:139]
    v_mfma_f32_16x16x32_bf16 v[144:147], v[24:27], v[64:67], v[144:147]
    v_mfma_f32_16x16x32_bf16 v[152:155], v[28:31], v[64:67], v[152:155]
    v_mfma_f32_16x16x32_bf16 v[192:195], v[20:23], v[20:23], v[192:195]
    v_mfma_f32_16x16x32_bf16 v[196:199], v[24:27], v[24:27], v[196:199]
    v_mfma_f32_16x16x32_bf16 v[200:203], v[28:31], v[28:31], v[200:203]
    s_waitcnt lgkmcnt(0)
    v_mfma_f32_16x16x32_bf16 v[92:95], v[68:71], v[36:39], v[92:95]
    v_cndmask_b32 v32, v32, v16, s[74:75]
    v_cndmask_b32 v33, v33, v16, s[74:75]
    v_mfma_f32_16x16x32_bf16 v[100:103], v[68:71], v[40:43], v[100:103]
    v_cndmask_b32 v34, v34, v16, s[74:75]
    s_add_u32 m0, s62, 149504
    s_add_u32 s46, s45, 1792
    buffer_load_dwordx4 v5, s[12:15], s46 offen lds
    v_cndmask_b32 v35, v35, v16, s[74:75]
    v_mfma_f32_16x16x32_bf16 v[96:99], v[72:75], v[36:39], v[96:99]
    v_cndmask_b32 v80, v80, v16, s[80:81]
    v_cndmask_b32 v81, v81, v16, s[80:81]
    v_mfma_f32_16x16x32_bf16 v[104:107], v[72:75], v[40:43], v[104:107]
    v_cndmask_b32 v82, v82, v16, s[80:81]
    v_cndmask_b32 v83, v83, v16, s[80:81]
    s_waitcnt vmcnt(13)
    s_barrier
    v_add_u32 v6, 30720, v6
    v_add_u32 v7, 30720, v7
    v_add_u32 v8, 30720, v8
    v_add_u32 v9, 30720, v9
    v_mfma_f32_16x16x32_bf16 v[156:159], v[68:71], v[16:19], v[156:159]
    ds_read_b128 v[20:23], v6 offset:0
    v_mfma_f32_16x16x32_bf16 v[160:163], v[72:75], v[16:19], v[160:163]
    ds_read_b128 v[24:27], v6 offset:2048
    s_add_u32 m0, s62, 131072
    s_add_u32 s46, s44, 28672
    buffer_load_dwordx4 v3, s[8:11], s46 offen lds
    v_mfma_f32_16x16x32_bf16 v[108:111], v[76:79], v[32:35], v[108:111]
    ds_read_b128 v[28:31], v6 offset:4096
    v_mfma_f32_16x16x32_bf16 v[116:119], v[76:79], v[36:39], v[116:119]
    ds_read_b64_tr_b16 v[44:45], v8 offset:0
    v_mfma_f32_16x16x32_bf16 v[124:127], v[76:79], v[40:43], v[124:127]
    ds_read_b64_tr_b16 v[46:47], v8 offset:256
    v_mfma_f32_16x16x32_bf16 v[112:115], v[80:83], v[32:35], v[112:115]
    ds_read_b64_tr_b16 v[48:49], v9 offset:0
    s_add_u32 m0, s62, 135168
    s_add_u32 s46, s44, 57344
    buffer_load_dwordx4 v3, s[8:11], s46 offen lds
    v_mfma_f32_16x16x32_bf16 v[120:123], v[80:83], v[36:39], v[120:123]
    ds_read_b64_tr_b16 v[50:51], v9 offset:256
    v_mfma_f32_16x16x32_bf16 v[128:131], v[80:83], v[40:43], v[128:131]
    ds_read_b64_tr_b16 v[52:53], v8 offset:4096
    v_mfma_f32_16x16x32_bf16 v[132:135], v[32:35], v[84:87], v[132:135]
    ds_read_b64_tr_b16 v[54:55], v8 offset:4352
    v_mfma_f32_16x16x32_bf16 v[140:143], v[36:39], v[84:87], v[140:143]
    ds_read_b64_tr_b16 v[56:57], v9 offset:4096
    s_add_u32 m0, s63, 139264
    s_mov_b32 s46, s44
    s_mov_b32 exec_hi, 0
    buffer_load_dwordx4 v4, s[8:11], s46 offen lds
    s_mov_b32 exec_hi, -1
    v_mfma_f32_16x16x32_bf16 v[148:151], v[40:43], v[84:87], v[148:151]
    ds_read_b64_tr_b16 v[58:59], v9 offset:4352
    v_mfma_f32_16x16x32_bf16 v[136:139], v[32:35], v[88:91], v[136:139]
    ds_read_b64_tr_b16 v[60:61], v8 offset:8192
    v_mfma_f32_16x16x32_bf16 v[144:147], v[36:39], v[88:91], v[144:147]
    ds_read_b64_tr_b16 v[62:63], v8 offset:8448
    v_mfma_f32_16x16x32_bf16 v[152:155], v[40:43], v[88:91], v[152:155]
    ds_read_b64_tr_b16 v[64:65], v9 offset:8192
    v_mfma_f32_16x16x32_bf16 v[192:195], v[32:35], v[32:35], v[192:195]
    ds_read_b64_tr_b16 v[66:67], v9 offset:8448
    v_mfma_f32_16x16x32_bf16 v[196:199], v[36:39], v[36:39], v[196:199]
    v_mfma_f32_16x16x32_bf16 v[200:203], v[40:43], v[40:43], v[200:203]
    s_waitcnt lgkmcnt(0)
    v_mfma_f32_16x16x32_bf16 v[92:95], v[44:47], v[24:27], v[92:95]
    v_cndmask_b32 v20, v20, v16, s[74:75]
    v_cndmask_b32 v21, v21, v16, s[74:75]
    ds_read_b128 v[32:35], v7 offset:0
    v_mfma_f32_16x16x32_bf16 v[100:103], v[44:47], v[28:31], v[100:103]
    s_add_u32 s44, s44, 128
    s_add_u32 s45, s45, 172032
    s_cmp_eq_u32 s44, 896
    s_cselect_b32 s44, 0, s44
    s_cselect_b32 s45, 0, s45
    s_add_u32 m0, s62, 18432
    s_mov_b32 s46, s45
    buffer_load_dwordx4 v5, s[12:15], s46 offen lds
    v_cndmask_b32 v22, v22, v16, s[74:75]
    v_cndmask_b32 v23, v23, v16, s[74:75]
    ds_read_b128 v[36:39], v7 offset:2048
    v_mfma_f32_16x16x32_bf16 v[96:99], v[48:51], v[24:27], v[96:99]
    v_cndmask_b32 v56, v56, v16, s[80:81]
    v_cndmask_b32 v57, v57, v16, s[80:81]
    ds_read_b128 v[40:43], v7 offset:4096
    v_mfma_f32_16x16x32_bf16 v[104:107], v[48:51], v[28:31], v[104:107]
    v_cndmask_b32 v58, v58, v16, s[80:81]
    v_cndmask_b32 v59, v59, v16, s[80:81]
    s_add_u32 m0, s62, 0
    s_mov_b32 s46, s44
    buffer_load_dwordx4 v2, s[8:11], s46 offen lds
    ds_read_b64_tr_b16 v[68:69], v8 offset:2048
    v_mfma_f32_16x16x32_bf16 v[156:159], v[44:47], v[16:19], v[156:159]
    ds_read_b64_tr_b16 v[70:71], v8 offset:2304
    v_mfma_f32_16x16x32_bf16 v[160:163], v[48:51], v[16:19], v[160:163]
    ds_read_b64_tr_b16 v[72:73], v9 offset:2048
    v_mfma_f32_16x16x32_bf16 v[108:111], v[52:55], v[20:23], v[108:111]
    ds_read_b64_tr_b16 v[74:75], v9 offset:2304
    v_mfma_f32_16x16x32_bf16 v[116:119], v[52:55], v[24:27], v[116:119]
    ds_read_b64_tr_b16 v[76:77], v8 offset:6144
    v_mfma_f32_16x16x32_bf16 v[124:127], v[52:55], v[28:31], v[124:127]
    s_add_u32 m0, s62, 22528
    s_add_u32 s46, s45, 896
    buffer_load_dwordx4 v5, s[12:15], s46 offen lds
    ds_read_b64_tr_b16 v[78:79], v8 offset:6400
    v_mfma_f32_16x16x32_bf16 v[112:115], v[56:59], v[20:23], v[112:115]
    ds_read_b64_tr_b16 v[80:81], v9 offset:6144
    v_mfma_f32_16x16x32_bf16 v[120:123], v[56:59], v[24:27], v[120:123]
    ds_read_b64_tr_b16 v[82:83], v9 offset:6400
    v_mfma_f32_16x16x32_bf16 v[128:131], v[56:59], v[28:31], v[128:131]
    ds_read_b64_tr_b16 v[84:85], v8 offset:10240
    v_mfma_f32_16x16x32_bf16 v[132:135], v[20:23], v[60:63], v[132:135]
    ds_read_b64_tr_b16 v[86:87], v8 offset:10496
    v_mfma_f32_16x16x32_bf16 v[140:143], v[24:27], v[60:63], v[140:143]
    s_add_u32 m0, s62, 4096
    s_mov_b32 s46, s44
    buffer_load_dwordx4 v3, s[8:11], s46 offen lds
    ds_read_b64_tr_b16 v[88:89], v9 offset:10240
    v_mfma_f32_16x16x32_bf16 v[148:151], v[28:31], v[60:63], v[148:151]
    ds_read_b64_tr_b16 v[90:91], v9 offset:10496
    v_mfma_f32_16x16x32_bf16 v[136:139], v[20:23], v[64:67], v[136:139]
    v_mfma_f32_16x16x32_bf16 v[144:147], v[24:27], v[64:67], v[144:147]
    v_mfma_f32_16x16x32_bf16 v[152:155], v[28:31], v[64:67], v[152:155]
    v_mfma_f32_16x16x32_bf16 v[192:195], v[20:23], v[20:23], v[192:195]
    v_mfma_f32_16x16x32_bf16 v[196:199], v[24:27], v[24:27], v[196:199]
    v_mfma_f32_16x16x32_bf16 v[200:203], v[28:31], v[28:31], v[200:203]
    s_waitcnt lgkmcnt(0)
    v_mfma_f32_16x16x32_bf16 v[92:95], v[68:71], v[36:39], v[92:95]
    v_cndmask_b32 v32, v32, v16, s[74:75]
    v_cndmask_b32 v33, v33, v16, s[74:75]
    v_mfma_f32_16x16x32_bf16 v[100:103], v[68:71], v[40:43], v[100:103]
    v_cndmask_b32 v34, v34, v16, s[74:75]
    s_add_u32 m0, s62, 26624
    s_add_u32 s46, s45, 1792
    buffer_load_dwordx4 v5, s[12:15], s46 offen lds
    v_cndmask_b32 v35, v35, v16, s[74:75]
    v_mfma_f32_16x16x32_bf16 v[96:99], v[72:75], v[36:39], v[96:99]
    v_cndmask_b32 v80, v80, v16, s[80:81]
    v_cndmask_b32 v81, v81, v16, s[80:81]
    v_mfma_f32_16x16x32_bf16 v[104:107], v[72:75], v[40:43], v[104:107]
    v_cndmask_b32 v82, v82, v16, s[80:81]
    v_cndmask_b32 v83, v83, v16, s[80:81]
    s_waitcnt vmcnt(13)
    s_barrier
    v_add_u32 v6, 30720, v6
    v_add_u32 v7, 30720, v7
    v_add_u32 v8, 30720, v8
    v_add_u32 v9, 30720, v9
    v_mfma_f32_16x16x32_bf16 v[156:159], v[68:71], v[16:19], v[156:159]
    ds_read_b128 v[20:23], v6 offset:0
    v_mfma_f32_16x16x32_bf16 v[160:163], v[72:75], v[16:19], v[160:163]
    ds_read_b128 v[24:27], v6 offset:2048
    s_add_u32 m0, s62, 8192
    s_add_u32 s46, s44, 28672
    buffer_load_dwordx4 v3, s[8:11], s46 offen lds
    v_mfma_f32_16x16x32_bf16 v[108:111], v[76:79], v[32:35], v[108:111]
    ds_read_b128 v[28:31], v6 offset:4096
    v_mfma_f32_16x16x32_bf16 v[116:119], v[76:79], v[36:39], v[116:119]
    ds_read_b64_tr_b16 v[44:45], v8 offset:0
    v_mfma_f32_16x16x32_bf16 v[124:127], v[76:79], v[40:43], v[124:127]
    ds_read_b64_tr_b16 v[46:47], v8 offset:256
    v_mfma_f32_16x16x32_bf16 v[112:115], v[80:83], v[32:35], v[112:115]
    ds_read_b64_tr_b16 v[48:49], v9 offset:0
    s_add_u32 m0, s62, 12288
    s_add_u32 s46, s44, 57344
    buffer_load_dwordx4 v3, s[8:11], s46 offen lds
    v_mfma_f32_16x16x32_bf16 v[120:123], v[80:83], v[36:39], v[120:123]
    ds_read_b64_tr_b16 v[50:51], v9 offset:256
    v_mfma_f32_16x16x32_bf16 v[128:131], v[80:83], v[40:43], v[128:131]
    ds_read_b64_tr_b16 v[52:53], v8 offset:4096
    v_mfma_f32_16x16x32_bf16 v[132:135], v[32:35], v[84:87], v[132:135]
    ds_read_b64_tr_b16 v[54:55], v8 offset:4352
    v_mfma_f32_16x16x32_bf16 v[140:143], v[36:39], v[84:87], v[140:143]
    ds_read_b64_tr_b16 v[56:57], v9 offset:4096
    s_add_u32 m0, s63, 16384
    s_mov_b32 s46, s44
    s_mov_b32 exec_hi, 0
    buffer_load_dwordx4 v4, s[8:11], s46 offen lds
    s_mov_b32 exec_hi, -1
    v_mfma_f32_16x16x32_bf16 v[148:151], v[40:43], v[84:87], v[148:151]
    ds_read_b64_tr_b16 v[58:59], v9 offset:4352
    v_mfma_f32_16x16x32_bf16 v[136:139], v[32:35], v[88:91], v[136:139]
    ds_read_b64_tr_b16 v[60:61], v8 offset:8192
    v_mfma_f32_16x16x32_bf16 v[144:147], v[36:39], v[88:91], v[144:147]
    ds_read_b64_tr_b16 v[62:63], v8 offset:8448
    v_mfma_f32_16x16x32_bf16 v[152:155], v[40:43], v[88:91], v[152:155]
    ds_read_b64_tr_b16 v[64:65], v9 offset:8192
    v_mfma_f32_16x16x32_bf16 v[192:195], v[32:35], v[32:35], v[192:195]
    ds_read_b64_tr_b16 v[66:67], v9 offset:8448
    v_mfma_f32_16x16x32_bf16 v[196:199], v[36:39], v[36:39], v[196:199]
    v_mfma_f32_16x16x32_bf16 v[200:203], v[40:43], v[40:43], v[200:203]
    s_waitcnt lgkmcnt(0)
    v_mfma_f32_16x16x32_bf16 v[92:95], v[44:47], v[24:27], v[92:95]
    v_cndmask_b32 v20, v20, v16, s[74:75]
    v_cndmask_b32 v21, v21, v16, s[74:75]
    ds_read_b128 v[32:35], v7 offset:0
    v_mfma_f32_16x16x32_bf16 v[100:103], v[44:47], v[28:31], v[100:103]
    s_add_u32 s44, s44, 128
    s_add_u32 s45, s45, 172032
    s_cmp_eq_u32 s44, 896
    s_cselect_b32 s44, 0, s44
    s_cselect_b32 s45, 0, s45
    s_add_u32 m0, s62, 49152
    s_mov_b32 s46, s45
    buffer_load_dwordx4 v5, s[12:15], s46 offen lds
    v_cndmask_b32 v22, v22, v16, s[74:75]
    v_cndmask_b32 v23, v23, v16, s[74:75]
    ds_read_b128 v[36:39], v7 offset:2048
    v_mfma_f32_16x16x32_bf16 v[96:99], v[48:51], v[24:27], v[96:99]
    v_cndmask_b32 v56, v56, v16, s[80:81]
    v_cndmask_b32 v57, v57, v16, s[80:81]
    ds_read_b128 v[40:43], v7 offset:4096
    v_mfma_f32_16x16x32_bf16 v[104:107], v[48:51], v[28:31], v[104:107]
    v_cndmask_b32 v58, v58, v16, s[80:81]
    v_cndmask_b32 v59, v59, v16, s[80:81]
    s_add_u32 m0, s62, 30720
    s_mov_b32 s46, s44
    buffer_load_dwordx4 v2, s[8:11], s46 offen lds
    ds_read_b64_tr_b16 v[68:69], v8 offset:2048
    v_mfma_f32_16x16x32_bf16 v[156:159], v[44:47], v[16:19], v[156:159]
    ds_read_b64_tr_b16 v[70:71], v8 offset:2304
    v_mfma_f32_16x16x32_bf16 v[160:163], v[48:51], v[16:19], v[160:163]
    ds_read_b64_tr_b16 v[72:73], v9 offset:2048
    v_mfma_f32_16x16x32_bf16 v[108:111], v[52:55], v[20:23], v[108:111]
    ds_read_b64_tr_b16 v[74:75], v9 offset:2304
    v_mfma_f32_16x16x32_bf16 v[116:119], v[52:55], v[24:27], v[116:119]
    ds_read_b64_tr_b16 v[76:77], v8 offset:6144
    v_mfma_f32_16x16x32_bf16 v[124:127], v[52:55], v[28:31], v[124:127]
    s_add_u32 m0, s62, 53248
    s_add_u32 s46, s45, 896
    buffer_load_dwordx4 v5, s[12:15], s46 offen lds
    ds_read_b64_tr_b16 v[78:79], v8 offset:6400
    v_mfma_f32_16x16x32_bf16 v[112:115], v[56:59], v[20:23], v[112:115]
    ds_read_b64_tr_b16 v[80:81], v9 offset:6144
    v_mfma_f32_16x16x32_bf16 v[120:123], v[56:59], v[24:27], v[120:123]
    ds_read_b64_tr_b16 v[82:83], v9 offset:6400
    v_mfma_f32_16x16x32_bf16 v[128:131], v[56:59], v[28:31], v[128:131]
    ds_read_b64_tr_b16 v[84:85], v8 offset:10240
    v_mfma_f32_16x16x32_bf16 v[132:135], v[20:23], v[60:63], v[132:135]
    ds_read_b64_tr_b16 v[86:87], v8 offset:10496
    v_mfma_f32_16x16x32_bf16 v[140:143], v[24:27], v[60:63], v[140:143]
    s_add_u32 m0, s62, 34816
    s_mov_b32 s46, s44
    buffer_load_dwordx4 v3, s[8:11], s46 offen lds
    ds_read_b64_tr_b16 v[88:89], v9 offset:10240
    v_mfma_f32_16x16x32_bf16 v[148:151], v[28:31], v[60:63], v[148:151]
    ds_read_b64_tr_b16 v[90:91], v9 offset:10496
    v_mfma_f32_16x16x32_bf16 v[136:139], v[20:23], v[64:67], v[136:139]
    v_mfma_f32_16x16x32_bf16 v[144:147], v[24:27], v[64:67], v[144:147]
    v_mfma_f32_16x16x32_bf16 v[152:155], v[28:31], v[64:67], v[152:155]
    v_mfma_f32_16x16x32_bf16 v[192:195], v[20:23], v[20:23], v[192:195]
    v_mfma_f32_16x16x32_bf16 v[196:199], v[24:27], v[24:27], v[196:199]
    v_mfma_f32_16x16x32_bf16 v[200:203], v[28:31], v[28:31], v[200:203]
    s_waitcnt lgkmcnt(0)
    s_lshr_b32 s36, s2, 3
    s_lshl_b32 s36, s36, 2
    s_add_u32 s36, s36, s3
    s_mul_hi_u32 s37, s36, 0x24924925
    s_mul_i32 s38, s37, 7
    s_sub_u32 s38, s36, s38
    s_lshl_b32 s38, s38, 7
    s_mul_i32 s37, s37, 57344
    s_add_u32 s37, s37, s38
    s_cmp_lt_u32 s36, 49
    s_cselect_b32 s37, s37, 0x7f000000
    s_movk_i32 s38, 896
    v_mul_u32_u24 v13, s38, v1
    buffer_load_dword v254, v13, s[4:7], s37 offen
    s_cmp_lg_u32 s3, 0
    s_cbranch_scc1 OW_4
    v_and_b32 v14, 15, v1
    v_lshlrev_b32 v14, 2, v14
    buffer_load_dword v15, v14, s[28:31], 0 offen sc1
OW_4:
    v_mfma_f32_16x16x32_bf16 v[92:95], v[68:71], v[36:39], v[92:95]
    v_cndmask_b32 v32, v32, v16, s[74:75]
    v_cndmask_b32 v33, v33, v16, s[74:75]
    v_mfma_f32_16x16x32_bf16 v[100:103], v[68:71], v[40:43], v[100:103]
    v_cndmask_b32 v34, v34, v16, s[74:75]
    s_add_u32 m0, s62, 57344
    s_add_u32 s46, s45, 1792
    buffer_load_dwordx4 v5, s[12:15], s46 offen lds
    v_cndmask_b32 v35, v35, v16, s[74:75]
    v_mfma_f32_16x16x32_bf16 v[96:99], v[72:75], v[36:39], v[96:99]
    v_cndmask_b32 v80, v80, v16, s[80:81]
    v_cndmask_b32 v81, v81, v16, s[80:81]
    v_mfma_f32_16x16x32_bf16 v[104:107], v[72:75], v[40:43], v[104:107]
    v_cndmask_b32 v82, v82, v16, s[80:81]
    v_cndmask_b32 v83, v83, v16, s[80:81]
    s_waitcnt vmcnt(14)
    s_barrier
    v_add_u32 v6, 30720, v6
    v_add_u32 v7, 30720, v7
    v_add_u32 v8, 30720, v8
    v_add_u32 v9, 30720, v9
    v_mfma_f32_16x16x32_bf16 v[156:159], v[68:71], v[16:19], v[156:159]
    ds_read_b128 v[20:23], v6 offset:0
    v_mfma_f32_16x16x32_bf16 v[160:163], v[72:75], v[16:19], v[160:163]
    ds_read_b128 v[24:27], v6 offset:2048
    s_add_u32 m0, s62, 38912
    s_add_u32 s46, s44, 28672
    buffer_load_dwordx4 v3, s[8:11], s46 offen lds
    v_mfma_f32_16x16x32_bf16 v[108:111], v[76:79], v[32:35], v[108:111]
    ds_read_b128 v[28:31], v6 offset:4096
    v_mfma_f32_16x16x32_bf16 v[116:119], v[76:79], v[36:39], v[116:119]
    ds_read_b64_tr_b16 v[44:45], v8 offset:0
    v_mfma_f32_16x16x32_bf16 v[124:127], v[76:79], v[40:43], v[124:127]
    ds_read_b64_tr_b16 v[46:47], v8 offset:256
    v_mfma_f32_16x16x32_bf16 v[112:115], v[80:83], v[32:35], v[112:115]
    ds_read_b64_tr_b16 v[48:49], v9 offset:0
    s_add_u32 m0, s62, 43008
    s_add_u32 s46, s44, 57344
    buffer_load_dwordx4 v3, s[8:11], s46 offen lds
    v_mfma_f32_16x16x32_bf16 v[120:123], v[80:83], v[36:39], v[120:123]
    ds_read_b64_tr_b16 v[50:51], v9 offset:256
    v_mfma_f32_16x16x32_bf16 v[128:131], v[80:83], v[40:43], v[128:131]
    ds_read_b64_tr_b16 v[52:53], v8 offset:4096
    v_mfma_f32_16x16x32_bf16 v[132:135], v[32:35], v[84:87], v[132:135]
    ds_read_b64_tr_b16 v[54:55], v8 offset:4352
    v_mfma_f32_16x16x32_bf16 v[140:143], v[36:39], v[84:87], v[140:143]
    ds_read_b64_tr_b16 v[56:57], v9 offset:4096
    s_add_u32 m0, s63, 47104
    s_mov_b32 s46, s44
    s_mov_b32 exec_hi, 0
    buffer_load_dwordx4 v4, s[8:11], s46 offen lds
    s_mov_b32 exec_hi, -1
    v_mfma_f32_16x16x32_bf16 v[148:151], v[40:43], v[84:87], v[148:151]
    ds_read_b64_tr_b16 v[58:59], v9 offset:4352
    v_mfma_f32_16x16x32_bf16 v[136:139], v[32:35], v[88:91], v[136:139]
    ds_read_b64_tr_b16 v[60:61], v8 offset:8192
    v_mfma_f32_16x16x32_bf16 v[144:147], v[36:39], v[88:91], v[144:147]
    ds_read_b64_tr_b16 v[62:63], v8 offset:8448
    v_mfma_f32_16x16x32_bf16 v[152:155], v[40:43], v[88:91], v[152:155]
    ds_read_b64_tr_b16 v[64:65], v9 offset:8192
    v_mfma_f32_16x16x32_bf16 v[192:195], v[32:35], v[32:35], v[192:195]
    ds_read_b64_tr_b16 v[66:67], v9 offset:8448
    v_mfma_f32_16x16x32_bf16 v[196:199], v[36:39], v[36:39], v[196:199]
    v_mfma_f32_16x16x32_bf16 v[200:203], v[40:43], v[40:43], v[200:203]
    s_waitcnt lgkmcnt(0)
    v_mfma_f32_16x16x32_bf16 v[92:95], v[44:47], v[24:27], v[92:95]
    v_cndmask_b32 v20, v20, v16, s[74:75]
    v_cndmask_b32 v21, v21, v16, s[74:75]
    ds_read_b128 v[32:35], v7 offset:0
    v_mfma_f32_16x16x32_bf16 v[100:103], v[44:47], v[28:31], v[100:103]
    v_cndmask_b32 v22, v22, v16, s[74:75]
    v_cndmask_b32 v23, v23, v16, s[74:75]
    ds_read_b128 v[36:39], v7 offset:2048
    v_mfma_f32_16x16x32_bf16 v[96:99], v[48:51], v[24:27], v[96:99]
    v_cndmask_b32 v56, v56, v16, s[80:81]
    v_cndmask_b32 v57, v57, v16, s[80:81]
    ds_read_b128 v[40:43], v7 offset:4096
    v_mfma_f32_16x16x32_bf16 v[104:107], v[48:51], v[28:31], v[104:107]
    v_cndmask_b32 v58, v58, v16, s[80:81]
    v_cndmask_b32 v59, v59, v16, s[80:81]
    ds_read_b64_tr_b16 v[68:69], v8 offset:2048
    v_mfma_f32_16x16x32_bf16 v[156:159], v[44:47], v[16:19], v[156:159]
    ds_read_b64_tr_b16 v[70:71], v8 offset:2304
    v_mfma_f32_16x16x32_bf16 v[160:163], v[48:51], v[16:19], v[160:163]
    ds_read_b64_tr_b16 v[72:73], v9 offset:2048
    v_mfma_f32_16x16x32_bf16 v[108:111], v[52:55], v[20:23], v[108:111]
    ds_read_b64_tr_b16 v[74:75], v9 offset:2304
    v_mfma_f32_16x16x32_bf16 v[116:119], v[52:55], v[24:27], v[116:119]
    ds_read_b64_tr_b16 v[76:77], v8 offset:6144
    v_mfma_f32_16x16x32_bf16 v[124:127], v[52:55], v[28:31], v[124:127]
    ds_read_b64_tr_b16 v[78:79], v8 offset:6400
    v_mfma_f32_16x16x32_bf16 v[112:115], v[56:59], v[20:23], v[112:115]
    ds_read_b64_tr_b16 v[80:81], v9 offset:6144
    v_mfma_f32_16x16x32_bf16 v[120:123], v[56:59], v[24:27], v[120:123]
    ds_read_b64_tr_b16 v[82:83], v9 offset:6400
    v_mfma_f32_16x16x32_bf16 v[128:131], v[56:59], v[28:31], v[128:131]
    ds_read_b64_tr_b16 v[84:85], v8 offset:10240
    v_mfma_f32_16x16x32_bf16 v[132:135], v[20:23], v[60:63], v[132:135]
    ds_read_b64_tr_b16 v[86:87], v8 offset:10496
    v_mfma_f32_16x16x32_bf16 v[140:143], v[24:27], v[60:63], v[140:143]
    ds_read_b64_tr_b16 v[88:89], v9 offset:10240
    v_mfma_f32_16x16x32_bf16 v[148:151], v[28:31], v[60:63], v[148:151]
    ds_read_b64_tr_b16 v[90:91], v9 offset:10496
    v_mfma_f32_16x16x32_bf16 v[136:139], v[20:23], v[64:67], v[136:139]
    v_mfma_f32_16x16x32_bf16 v[144:147], v[24:27], v[64:67], v[144:147]
    v_mfma_f32_16x16x32_bf16 v[152:155], v[28:31], v[64:67], v[152:155]
    v_mfma_f32_16x16x32_bf16 v[192:195], v[20:23], v[20:23], v[192:195]
    v_mfma_f32_16x16x32_bf16 v[196:199], v[24:27], v[24:27], v[196:199]
    v_mfma_f32_16x16x32_bf16 v[200:203], v[28:31], v[28:31], v[200:203]
    s_waitcnt lgkmcnt(0)
    v_mfma_f32_16x16x32_bf16 v[92:95], v[68:71], v[36:39], v[92:95]
    v_cndmask_b32 v32, v32, v16, s[74:75]
    v_cndmask_b32 v33, v33, v16, s[74:75]
    v_mfma_f32_16x16x32_bf16 v[100:103], v[68:71], v[40:43], v[100:103]
    v_cndmask_b32 v34, v34, v16, s[74:75]
    v_cndmask_b32 v35, v35, v16, s[74:75]
    v_mfma_f32_16x16x32_bf16 v[96:99], v[72:75], v[36:39], v[96:99]
    v_cndmask_b32 v80, v80, v16, s[80:81]
    v_cndmask_b32 v81, v81, v16, s[80:81]
    v_mfma_f32_16x16x32_bf16 v[104:107], v[72:75], v[40:43], v[104:107]
    v_cndmask_b32 v82, v82, v16, s[80:81]
    v_cndmask_b32 v83, v83, v16, s[80:81]
    s_waitcnt vmcnt(9)
    s_barrier
    v_add_u32 v6, 4294844416, v6
    v_add_u32 v7, 4294844416, v7
    v_add_u32 v8, 4294844416, v8
    v_add_u32 v9, 4294844416, v9
    v_mfma_f32_16x16x32_bf16 v[156:159], v[68:71], v[16:19], v[156:159]
    ds_read_b128 v[20:23], v6 offset:0
    v_mfma_f32_16x16x32_bf16 v[160:163], v[72:75], v[16:19], v[160:163]
    ds_read_b128 v[24:27], v6 offset:2048
    v_mfma_f32_16x16x32_bf16 v[108:111], v[76:79], v[32:35], v[108:111]
    ds_read_b128 v[28:31], v6 offset:4096
    v_mfma_f32_16x16x32_bf16 v[116:119], v[76:79], v[36:39], v[116:119]
    ds_read_b64_tr_b16 v[44:45], v8 offset:0
    v_mfma_f32_16x16x32_bf16 v[124:127], v[76:79], v[40:43], v[124:127]
    ds_read_b64_tr_b16 v[46:47], v8 offset:256
    v_mfma_f32_16x16x32_bf16 v[112:115], v[80:83], v[32:35], v[112:115]
    ds_read_b64_tr_b16 v[48:49], v9 offset:0
    v_mfma_f32_16x16x32_bf16 v[120:123], v[80:83], v[36:39], v[120:123]
    ds_read_b64_tr_b16 v[50:51], v9 offset:256
    v_mfma_f32_16x16x32_bf16 v[128:131], v[80:83], v[40:43], v[128:131]
    ds_read_b64_tr_b16 v[52:53], v8 offset:4096
    v_mfma_f32_16x16x32_bf16 v[132:135], v[32:35], v[84:87], v[132:135]
    ds_read_b64_tr_b16 v[54:55], v8 offset:4352
    v_mfma_f32_16x16x32_bf16 v[140:143], v[36:39], v[84:87], v[140:143]
    ds_read_b64_tr_b16 v[56:57], v9 offset:4096
    v_mfma_f32_16x16x32_bf16 v[148:151], v[40:43], v[84:87], v[148:151]
    ds_read_b64_tr_b16 v[58:59], v9 offset:4352
    v_mfma_f32_16x16x32_bf16 v[136:139], v[32:35], v[88:91], v[136:139]
    ds_read_b64_tr_b16 v[60:61], v8 offset:8192
    v_mfma_f32_16x16x32_bf16 v[144:147], v[36:39], v[88:91], v[144:147]
    ds_read_b64_tr_b16 v[62:63], v8 offset:8448
    v_mfma_f32_16x16x32_bf16 v[152:155], v[40:43], v[88:91], v[152:155]
    ds_read_b64_tr_b16 v[64:65], v9 offset:8192
    v_mfma_f32_16x16x32_bf16 v[192:195], v[32:35], v[32:35], v[192:195]
    ds_read_b64_tr_b16 v[66:67], v9 offset:8448
    v_mfma_f32_16x16x32_bf16 v[196:199], v[36:39], v[36:39], v[196:199]
    v_mfma_f32_16x16x32_bf16 v[200:203], v[40:43], v[40:43], v[200:203]
    s_cmp_eq_u32 s35, 7
    s_cselect_b32 s26, 0, s26
    s_cselect_b32 s6, 0, s6
    s_lshl_b32 s40, s35, 7
    s_mul_i32 s41, s3, 7168
    s_add_u32 s40, s40, s41
    s_add_u32 s41, s62, 106496
    s_waitcnt lgkmcnt(0)
    v_mfma_f32_16x16x32_bf16 v[92:95], v[44:47], v[24:27], v[92:95]
    v_cndmask_b32 v20, v20, v16, s[74:75]
    v_cndmask_b32 v21, v21, v16, s[74:75]
    s_add_u32 m0, s41, 0
    s_add_u32 s46, s40, 0
    buffer_load_dwordx4 v252, s[4:7], s46 offen lds
    ds_read_b128 v[32:35], v7 offset:0
    v_mfma_f32_16x16x32_bf16 v[100:103], v[44:47], v[28:31], v[100:103]
    v_cndmask_b32 v22, v22, v16, s[74:75]
    v_cndmask_b32 v23, v23, v16, s[74:75]
    ds_read_b128 v[36:39], v7 offset:2048
    s_add_u32 m0, s41, 4096
    s_add_u32 s46, s40, 28672
    buffer_load_dwordx4 v252, s[4:7], s46 offen lds
    v_mfma_f32_16x16x32_bf16 v[96:99], v[48:51], v[24:27], v[96:99]
    v_cndmask_b32 v56, v56, v16, s[80:81]
    v_cndmask_b32 v57, v57, v16, s[80:81]
    ds_read_b128 v[40:43], v7 offset:4096
    v_mfma_f32_16x16x32_bf16 v[104:107], v[48:51], v[28:31], v[104:107]
    s_add_u32 m0, s41, 8192
    s_add_u32 s46, s40, 57344
    buffer_load_dwordx4 v252, s[4:7], s46 offen lds
    v_cndmask_b32 v58, v58, v16, s[80:81]
    v_cndmask_b32 v59, v59, v16, s[80:81]
    ds_read_b64_tr_b16 v[68:69], v8 offset:2048
    v_mfma_f32_16x16x32_bf16 v[156:159], v[44:47], v[16:19], v[156:159]
    ds_read_b64_tr_b16 v[70:71], v8 offset:2304
    s_add_u32 m0, s41, 12288
    s_add_u32 s46, s40, 86016
    buffer_load_dwordx4 v252, s[4:7], s46 offen lds
    v_mfma_f32_16x16x32_bf16 v[160:163], v[48:51], v[16:19], v[160:163]
    ds_read_b64_tr_b16 v[72:73], v9 offset:2048
    v_mfma_f32_16x16x32_bf16 v[108:111], v[52:55], v[20:23], v[108:111]
    ds_read_b64_tr_b16 v[74:75], v9 offset:2304
    v_mfma_f32_16x16x32_bf16 v[116:119], v[52:55], v[24:27], v[116:119]
    s_add_u32 m0, s41, 16384
    s_add_u32 s46, s40, 114688
    buffer_load_dwordx4 v252, s[4:7], s46 offen lds
    ds_read_b64_tr_b16 v[76:77], v8 offset:6144
    v_mfma_f32_16x16x32_bf16 v[124:127], v[52:55], v[28:31], v[124:127]
    ds_read_b64_tr_b16 v[78:79], v8 offset:6400
    v_mfma_f32_16x16x32_bf16 v[112:115], v[56:59], v[20:23], v[112:115]
    ds_read_b64_tr_b16 v[80:81], v9 offset:6144
    s_add_u32 m0, s41, 20480
    s_add_u32 s46, s40, 143360
    buffer_load_dwordx4 v252, s[4:7], s46 offen lds
    v_mfma_f32_16x16x32_bf16 v[120:123], v[56:59], v[24:27], v[120:123]
    ds_read_b64_tr_b16 v[82:83], v9 offset:6400
    v_mfma_f32_16x16x32_bf16 v[128:131], v[56:59], v[28:31], v[128:131]
    ds_read_b64_tr_b16 v[84:85], v8 offset:10240
    v_mfma_f32_16x16x32_bf16 v[132:135], v[20:23], v[60:63], v[132:135]
    s_add_u32 m0, s41, 24576
    s_add_u32 s46, s40, 172032
    buffer_load_dwordx4 v252, s[4:7], s46 offen lds
    ds_read_b64_tr_b16 v[86:87], v8 offset:10496
    v_mfma_f32_16x16x32_bf16 v[140:143], v[24:27], v[60:63], v[140:143]
    ds_read_b64_tr_b16 v[88:89], v9 offset:10240
    v_mfma_f32_16x16x32_bf16 v[148:151], v[28:31], v[60:63], v[148:151]
    ds_read_b64_tr_b16 v[90:91], v9 offset:10496
    s_add_u32 m0, s41, 28672
    s_add_u32 s46, s40, 200704
    buffer_load_dwordx4 v252, s[4:7], s46 offen lds
    v_mfma_f32_16x16x32_bf16 v[136:139], v[20:23], v[64:67], v[136:139]
    v_mfma_f32_16x16x32_bf16 v[144:147], v[24:27], v[64:67], v[144:147]
    v_mfma_f32_16x16x32_bf16 v[152:155], v[28:31], v[64:67], v[152:155]
    v_mfma_f32_16x16x32_bf16 v[192:195], v[20:23], v[20:23], v[192:195]
    v_mfma_f32_16x16x32_bf16 v[196:199], v[24:27], v[24:27], v[196:199]
    v_mfma_f32_16x16x32_bf16 v[200:203], v[28:31], v[28:31], v[200:203]
    s_waitcnt lgkmcnt(0)
    v_mfma_f32_16x16x32_bf16 v[92:95], v[68:71], v[36:39], v[92:95]
    v_cndmask_b32 v32, v32, v16, s[74:75]
    v_cndmask_b32 v33, v33, v16, s[74:75]
    s_add_u32 m0, s41, 32768
    s_add_u32 s46, s40, 229376
    buffer_load_dwordx4 v252, s[4:7], s46 offen lds
    v_mfma_f32_16x16x32_bf16 v[100:103], v[68:71], v[40:43], v[100:103]
    v_cndmask_b32 v34, v34, v16, s[74:75]
    v_cndmask_b32 v35, v35, v16, s[74:75]
    v_mfma_f32_16x16x32_bf16 v[96:99], v[72:75], v[36:39], v[96:99]
    s_add_u32 m0, s41, 36864
    s_add_u32 s46, s40, 258048
    buffer_load_dwordx4 v252, s[4:7], s46 offen lds
    v_cndmask_b32 v80, v80, v16, s[80:81]
    v_cndmask_b32 v81, v81, v16, s[80:81]
    v_mfma_f32_16x16x32_bf16 v[104:107], v[72:75], v[40:43], v[104:107]
    v_cndmask_b32 v82, v82, v16, s[80:81]
    v_cndmask_b32 v83, v83, v16, s[80:81]
    s_waitcnt vmcnt(10)
    s_cmp_lg_u32 s3, 0
    s_cbranch_scc1 OW_5
    s_waitcnt vmcnt(14)
    v_and_b32 v14, 15, v1
    v_lshlrev_b32 v14, 2, v14
    s_mov_b32 s38, 0
HSl_6:
    v_cmp_ne_u32 vcc, 1, v15
    s_cbranch_vccz HSk_7
    s_sleep 1
    buffer_load_dword v15, v14, s[28:31], 0 offen sc1
    s_waitcnt vmcnt(0)
    s_add_u32 s38, s38, 1
    s_cmp_lt_u32 s38, 300000
    s_cbranch_scc1 HSl_6
HSk_7:
OW_5:
    s_barrier
    v_add_u32 v6, 30720, v6
    v_add_u32 v7, 30720, v7
    v_add_u32 v8, 30720, v8
    v_add_u32 v9, 30720, v9
    v_mfma_f32_16x16x32_bf16 v[156:159], v[68:71], v[16:19], v[156:159]
    ds_read_b128 v[20:23], v6 offset:0
    v_mfma_f32_16x16x32_bf16 v[160:163], v[72:75], v[16:19], v[160:163]
    ds_read_b128 v[24:27], v6 offset:2048
    s_add_u32 m0, s41, 40960
    s_add_u32 s46, s40, 286720
    buffer_load_dwordx4 v252, s[4:7], s46 offen lds
    v_mfma_f32_16x16x32_bf16 v[108:111], v[76:79], v[32:35], v[108:111]
    ds_read_b128 v[28:31], v6 offset:4096
    v_mfma_f32_16x16x32_bf16 v[116:119], v[76:79], v[36:39], v[116:119]
    ds_read_b64_tr_b16 v[44:45], v8 offset:0
    v_mfma_f32_16x16x32_bf16 v[124:127], v[76:79], v[40:43], v[124:127]
    s_add_u32 m0, s41, 45056
    s_add_u32 s46, s40, 315392
    buffer_load_dwordx4 v252, s[4:7], s46 offen lds
    ds_read_b64_tr_b16 v[46:47], v8 offset:256
    v_mfma_f32_16x16x32_bf16 v[112:115], v[80:83], v[32:35], v[112:115]
    ds_read_b64_tr_b16 v[48:49], v9 offset:0
    v_mfma_f32_16x16x32_bf16 v[120:123], v[80:83], v[36:39], v[120:123]
    ds_read_b64_tr_b16 v[50:51], v9 offset:256
    s_add_u32 m0, s41, 49152
    s_add_u32 s46, s40, 344064
    buffer_load_dwordx4 v252, s[4:7], s46 offen lds
    v_mfma_f32_16x16x32_bf16 v[128:131], v[80:83], v[40:43], v[128:131]
    ds_read_b64_tr_b16 v[52:53], v8 offset:4096
    v_mfma_f32_16x16x32_bf16 v[132:135], v[32:35], v[84:87], v[132:135]
    ds_read_b64_tr_b16 v[54:55], v8 offset:4352
    v_mfma_f32_16x16x32_bf16 v[140:143], v[36:39], v[84:87], v[140:143]
    s_add_u32 m0, s41, 53248
    s_add_u32 s46, s40, 372736
    buffer_load_dwordx4 v252, s[4:7], s46 offen lds
    ds_read_b64_tr_b16 v[56:57], v9 offset:4096
    v_mfma_f32_16x16x32_bf16 v[148:151], v[40:43], v[84:87], v[148:151]
    ds_read_b64_tr_b16 v[58:59], v9 offset:4352
    v_mfma_f32_16x16x32_bf16 v[136:139], v[32:35], v[88:91], v[136:139]
    ds_read_b64_tr_b16 v[60:61], v8 offset:8192
    v_mfma_f32_16x16x32_bf16 v[144:147], v[36:39], v[88:91], v[144:147]
    ds_read_b64_tr_b16 v[62:63], v8 offset:8448
    v_mfma_f32_16x16x32_bf16 v[152:155], v[40:43], v[88:91], v[152:155]
    ds_read_b64_tr_b16 v[64:65], v9 offset:8192
    v_mfma_f32_16x16x32_bf16 v[192:195], v[32:35], v[32:35], v[192:195]
    ds_read_b64_tr_b16 v[66:67], v9 offset:8448
    v_mfma_f32_16x16x32_bf16 v[196:199], v[36:39], v[36:39], v[196:199]
    v_mfma_f32_16x16x32_bf16 v[200:203], v[40:43], v[40:43], v[200:203]
    s_waitcnt lgkmcnt(0)
    v_mfma_f32_16x16x32_bf16 v[92:95], v[44:47], v[24:27], v[92:95]
    v_cndmask_b32 v20, v20, v16, s[74:75]
    v_cndmask_b32 v21, v21, v16, s[74:75]
    ds_read_b128 v[32:35], v7 offset:0
    v_mfma_f32_16x16x32_bf16 v[100:103], v[44:47], v[28:31], v[100:103]
    v_cndmask_b32 v22, v22, v16, s[74:75]
    v_cndmask_b32 v23, v23, v16, s[74:75]
    ds_read_b128 v[36:39], v7 offset:2048
    v_mfma_f32_16x16x32_bf16 v[96:99], v[48:51], v[24:27], v[96:99]
    v_cndmask_b32 v56, v56, v16, s[80:81]
    v_cndmask_b32 v57, v57, v16, s[80:81]
    ds_read_b128 v[40:43], v7 offset:4096
    v_mfma_f32_16x16x32_bf16 v[104:107], v[48:51], v[28:31], v[104:107]
    v_cndmask_b32 v58, v58, v16, s[80:81]
    v_cndmask_b32 v59, v59, v16, s[80:81]
    ds_read_b64_tr_b16 v[68:69], v8 offset:2048
    v_mfma_f32_16x16x32_bf16 v[156:159], v[44:47], v[16:19], v[156:159]
    ds_read_b64_tr_b16 v[70:71], v8 offset:2304
    v_mfma_f32_16x16x32_bf16 v[160:163], v[48:51], v[16:19], v[160:163]
    ds_read_b64_tr_b16 v[72:73], v9 offset:2048
    v_mfma_f32_16x16x32_bf16 v[108:111], v[52:55], v[20:23], v[108:111]
    ds_read_b64_tr_b16 v[74:75], v9 offset:2304
    v_mfma_f32_16x16x32_bf16 v[116:119], v[52:55], v[24:27], v[116:119]
    ds_read_b64_tr_b16 v[76:77], v8 offset:6144
    v_mfma_f32_16x16x32_bf16 v[124:127], v[52:55], v[28:31], v[124:127]
    ds_read_b64_tr_b16 v[78:79], v8 offset:6400
    v_mfma_f32_16x16x32_bf16 v[112:115], v[56:59], v[20:23], v[112:115]
    ds_read_b64_tr_b16 v[80:81], v9 offset:6144
    v_mfma_f32_16x16x32_bf16 v[120:123], v[56:59], v[24:27], v[120:123]
    ds_read_b64_tr_b16 v[82:83], v9 offset:6400
    v_mfma_f32_16x16x32_bf16 v[128:131], v[56:59], v[28:31], v[128:131]
    ds_read_b64_tr_b16 v[84:85], v8 offset:10240
    v_mfma_f32_16x16x32_bf16 v[132:135], v[20:23], v[60:63], v[132:135]
    ds_read_b64_tr_b16 v[86:87], v8 offset:10496
    v_mfma_f32_16x16x32_bf16 v[140:143], v[24:27], v[60:63], v[140:143]
    ds_read_b64_tr_b16 v[88:89], v9 offset:10240
    v_mfma_f32_16x16x32_bf16 v[148:151], v[28:31], v[60:63], v[148:151]
    ds_read_b64_tr_b16 v[90:91], v9 offset:10496
    v_mfma_f32_16x16x32_bf16 v[136:139], v[20:23], v[64:67], v[136:139]
    v_mfma_f32_16x16x32_bf16 v[144:147], v[24:27], v[64:67], v[144:147]
    v_mfma_f32_16x16x32_bf16 v[152:155], v[28:31], v[64:67], v[152:155]
    v_mfma_f32_16x16x32_bf16 v[192:195], v[20:23], v[20:23], v[192:195]
    v_mfma_f32_16x16x32_bf16 v[196:199], v[24:27], v[24:27], v[196:199]
    v_mfma_f32_16x16x32_bf16 v[200:203], v[28:31], v[28:31], v[200:203]
    s_waitcnt lgkmcnt(0)
    s_lshr_b32 s36, s2, 3
    s_lshl_b32 s36, s36, 2
    s_add_u32 s36, s36, s3
    s_mul_hi_u32 s37, s36, 306783379
    s_mul_i32 s38, s37, 14
    s_sub_u32 s38, s36, s38
    s_lshl_b32 s38, s38, 7
    s_mul_i32 s47, s34, 1792
    s_add_u32 s38, s38, s47
    s_mul_i32 s37, s37, 229376
    s_add_u32 s37, s37, s38
    s_cmp_lt_u32 s36, 98
    s_cselect_b32 s37, s37, 0x7f000000
    s_movk_i32 s38, 3584
    v_mul_u32_u24 v13, s38, v1
    buffer_load_dword v254, v13, s[84:87], s37 offen
    v_mfma_f32_16x16x32_bf16 v[92:95], v[68:71], v[36:39], v[92:95]
    v_cndmask_b32 v32, v32, v16, s[74:75]
    v_cndmask_b32 v33, v33, v16, s[74:75]
    v_mfma_f32_16x16x32_bf16 v[100:103], v[68:71], v[40:43], v[100:103]
    v_cndmask_b32 v34, v34, v16, s[74:75]
    v_cndmask_b32 v35, v35, v16, s[74:75]
    v_mfma_f32_16x16x32_bf16 v[96:99], v[72:75], v[36:39], v[96:99]
    v_cndmask_b32 v80, v80, v16, s[80:81]
    v_cndmask_b32 v81, v81, v16, s[80:81]
    v_mfma_f32_16x16x32_bf16 v[104:107], v[72:75], v[40:43], v[104:107]
    v_cndmask_b32 v82, v82, v16, s[80:81]
    v_cndmask_b32 v83, v83, v16, s[80:81]
    s_nop 1
    v_mfma_f32_16x16x32_bf16 v[112:115], v[80:83], v[32:35], v[112:115]
    v_mfma_f32_16x16x32_bf16 v[120:123], v[80:83], v[36:39], v[120:123]
    v_mfma_f32_16x16x32_bf16 v[128:131], v[80:83], v[40:43], v[128:131]
    v_mfma_f32_16x16x32_bf16 v[192:195], v[32:35], v[32:35], v[192:195]
    v_mfma_f32_16x16x32_bf16 v[196:199], v[36:39], v[36:39], v[196:199]
    v_mfma_f32_16x16x32_bf16 v[200:203], v[40:43], v[40:43], v[200:203]
    v_mfma_f32_16x16x32_bf16 v[156:159], v[68:71], v[16:19], v[156:159]
    v_mfma_f32_16x16x32_bf16 v[160:163], v[72:75], v[16:19], v[160:163]
    v_mfma_f32_16x16x32_bf16 v[108:111], v[76:79], v[32:35], v[108:111]
    s_add_u32 s36, s62, 98304
    v_and_b32 v13, 15, v1
    v_lshl_add_u32 v13, v13, 2, s36
    v_add_u32 v14, s36, v12
    v_mov_b32 v204, v112
    v_mov_b32 v15, v112
    s_nop 1
    v_permlane32_swap_b32 v15, v204
    v_mov_b32 v15, v204
    v_mfma_f32_16x16x32_bf16 v[116:119], v[76:79], v[36:39], v[116:119]
    s_nop 0
    v_permlane16_swap_b32 v15, v204
    v_mul_f32 v204, 0x3b124925, v204
    v_cndmask_b32 v205, v192, v193, s[66:67]
    v_cndmask_b32 v205, v205, v194, s[68:69]
    v_cndmask_b32 v205, v205, v195, s[70:71]
    ds_bpermute_b32 v205, v11, v205
    v_mov_b32 v206, v120
    v_mov_b32 v15, v120
    v_mfma_f32_16x16x32_bf16 v[124:127], v[76:79], v[40:43], v[124:127]
    s_nop 0
    v_permlane32_swap_b32 v15, v206
    v_mov_b32 v15, v206
    s_nop 1
    v_permlane16_swap_b32 v15, v206
    v_mul_f32 v206, 0x3b124925, v206
    v_cndmask_b32 v207, v196, v197, s[66:67]
    v_cndmask_b32 v207, v207, v198, s[68:69]
    v_cndmask_b32 v207, v207, v199, s[70:71]
    ds_bpermute_b32 v207, v11, v207
    v_mfma_f32_16x16x32_bf16 v[132:135], v[32:35], v[84:87], v[132:135]
    v_mov_b32 v208, v128
    v_mov_b32 v15, v128
    s_nop 1
    v_permlane32_swap_b32 v15, v208
    v_mov_b32 v15, v208
    s_nop 1
    v_permlane16_swap_b32 v15, v208
    v_mul_f32 v208, 0x3b124925, v208
    v_cndmask_b32 v209, v200, v201, s[66:67]
    v_cndmask_b32 v209, v209, v202, s[68:69]
    v_mfma_f32_16x16x32_bf16 v[140:143], v[36:39], v[84:87], v[140:143]
    v_cndmask_b32 v209, v209, v203, s[70:71]
    ds_bpermute_b32 v209, v11, v209
    ds_write_b32 v13, v204 offset:0
    ds_write_b32 v13, v206 offset:64
    ds_write_b32 v13, v208 offset:128
    v_mfma_f32_16x16x32_bf16 v[148:151], v[40:43], v[84:87], v[148:151]
    s_waitcnt lgkmcnt(3)
    s_mov_b32 s36, 0x3b124925
    v_mul_f32 v216, v204, v204
    v_mul_f32 v217, v206, v206
    v_mul_f32 v218, v208, v208
    v_mfma_f32_16x16x32_bf16 v[136:139], v[32:35], v[88:91], v[136:139]
    v_fma_f32 v216, v205, s36, -v216
    v_fma_f32 v217, v207, s36, -v217
    v_fma_f32 v218, v209, s36, -v218
    v_max_f32 v216, 0, v216
    v_max_f32 v217, 0, v217
    v_mfma_f32_16x16x32_bf16 v[144:147], v[36:39], v[88:91], v[144:147]
    v_max_f32 v218, 0, v218
    v_add_f32 v216, 0x3727c5ac, v216
    v_add_f32 v217, 0x3727c5ac, v217
    v_add_f32 v218, 0x3727c5ac, v218
    v_rsq_f32 v210, v216
    v_mfma_f32_16x16x32_bf16 v[152:155], v[40:43], v[88:91], v[152:155]
    v_rsq_f32 v212, v217
    v_rsq_f32 v214, v218
    ds_write_b32 v13, v210 offset:192
    ds_write_b32 v13, v212 offset:256
    ds_write_b32 v13, v214 offset:320
    ds_read_b128 v[20:23], v14 offset:0
    ds_read_b128 v[24:27], v14 offset:64
    ds_read_b128 v[28:31], v14 offset:128
    ds_read_b128 v[32:35], v14 offset:192
    ds_read_b128 v[36:39], v14 offset:256
    ds_read_b128 v[40:43], v14 offset:320
    v_mov_b32_dpp v164, v108 row_newbcast:0 row_mask:0xf bank_mask:0xf
    v_mov_b32_dpp v165, v109 row_newbcast:0 row_mask:0xf bank_mask:0xf
    v_mov_b32_dpp v166, v110 row_newbcast:0 row_mask:0xf bank_mask:0xf
    v_mov_b32_dpp v167, v111 row_newbcast:0 row_mask:0xf bank_mask:0xf
    v_mov_b32_dpp v168, v112 row_newbcast:0 row_mask:0xf bank_mask:0xf
    v_mov_b32_dpp v169, v113 row_newbcast:0 row_mask:0xf bank_mask:0xf
    v_mov_b32_dpp v170, v114 row_newbcast:0 row_mask:0xf bank_mask:0xf
    v_mov_b32_dpp v171, v115 row_newbcast:0 row_mask:0xf bank_mask:0xf
    v_mov_b32 v172, v132
    v_mov_b32 v15, v132
    s_nop 1
    v_permlane16_swap_b32 v172, v15
    v_mov_b32 v15, v172
    s_nop 1
    v_permlane32_swap_b32 v172, v15
    v_mov_b32 v176, v136
    v_mov_b32 v15, v136
    s_nop 1
    v_permlane16_swap_b32 v176, v15
    v_mov_b32 v15, v176
    s_nop 1
    v_permlane32_swap_b32 v176, v15
    s_lshl_b32 s40, s33, 8
    s_mul_i32 s41, s3, 14336
    s_add_u32 s40, s40, s41
    v_pk_fma_f32 v[92:93], v[206:207], v[156:157], v[92:93] op_sel_hi:[0,1,1] neg_lo:[1,0,0] neg_hi:[1,0,0]
    v_pk_fma_f32 v[94:95], v[206:207], v[158:159], v[94:95] op_sel_hi:[0,1,1] neg_lo:[1,0,0] neg_hi:[1,0,0]
    v_pk_fma_f32 v[96:97], v[206:207], v[160:161], v[96:97] op_sel_hi:[0,1,1] neg_lo:[1,0,0] neg_hi:[1,0,0]
    v_pk_fma_f32 v[98:99], v[206:207], v[162:163], v[98:99] op_sel_hi:[0,1,1] neg_lo:[1,0,0] neg_hi:[1,0,0]
    v_pk_fma_f32 v[100:101], v[208:209], v[156:157], v[100:101] op_sel_hi:[0,1,1] neg_lo:[1,0,0] neg_hi:[1,0,0]
    v_pk_fma_f32 v[102:103], v[208:209], v[158:159], v[102:103] op_sel_hi:[0,1,1] neg_lo:[1,0,0] neg_hi:[1,0,0]
    v_pk_fma_f32 v[104:105], v[208:209], v[160:161], v[104:105] op_sel_hi:[0,1,1] neg_lo:[1,0,0] neg_hi:[1,0,0]
    v_pk_fma_f32 v[106:107], v[208:209], v[162:163], v[106:107] op_sel_hi:[0,1,1] neg_lo:[1,0,0] neg_hi:[1,0,0]
    v_pk_fma_f32 v[108:109], v[204:205], v[164:165], v[108:109] op_sel_hi:[0,1,1] neg_lo:[1,0,0] neg_hi:[1,0,0]
    v_pk_fma_f32 v[110:111], v[204:205], v[166:167], v[110:111] op_sel_hi:[0,1,1] neg_lo:[1,0,0] neg_hi:[1,0,0]
    v_pk_fma_f32 v[112:113], v[204:205], v[168:169], v[112:113] op_sel_hi:[0,1,1] neg_lo:[1,0,0] neg_hi:[1,0,0]
    v_pk_fma_f32 v[114:115], v[204:205], v[170:171], v[114:115] op_sel_hi:[0,1,1] neg_lo:[1,0,0] neg_hi:[1,0,0]
    v_pk_fma_f32 v[116:117], v[206:207], v[164:165], v[116:117] op_sel_hi:[0,1,1] neg_lo:[1,0,0] neg_hi:[1,0,0]
    v_pk_fma_f32 v[118:119], v[206:207], v[166:167], v[118:119] op_sel_hi:[0,1,1] neg_lo:[1,0,0] neg_hi:[1,0,0]
    v_pk_fma_f32 v[120:121], v[206:207], v[168:169], v[120:121] op_sel_hi:[0,1,1] neg_lo:[1,0,0] neg_hi:[1,0,0]
    v_pk_fma_f32 v[122:123], v[206:207], v[170:171], v[122:123] op_sel_hi:[0,1,1] neg_lo:[1,0,0] neg_hi:[1,0,0]
    v_pk_fma_f32 v[124:125], v[208:209], v[164:165], v[124:125] op_sel_hi:[0,1,1] neg_lo:[1,0,0] neg_hi:[1,0,0]
    v_pk_fma_f32 v[126:127], v[208:209], v[166:167], v[126:127] op_sel_hi:[0,1,1] neg_lo:[1,0,0] neg_hi:[1,0,0]
    v_pk_fma_f32 v[128:129], v[208:209], v[168:169], v[128:129] op_sel_hi:[0,1,1] neg_lo:[1,0,0] neg_hi:[1,0,0]
    v_pk_fma_f32 v[130:131], v[208:209], v[170:171], v[130:131] op_sel_hi:[0,1,1] neg_lo:[1,0,0] neg_hi:[1,0,0]
    v_mul_f32 v216, 0x3e8b97f6, v212
    v_cndmask_b32 v218, v216, 0, s[64:65]
    v_mul_f32 v220, 0x3e8b97f6, v214
    v_cndmask_b32 v222, v220, 0, s[64:65]
    v_pk_mul_f32 v[108:109], v[210:211], v[108:109] op_sel_hi:[0,1]
    v_pk_mul_f32 v[110:111], v[210:211], v[110:111] op_sel_hi:[0,1]
    v_cvt_pk_bf16_f32 v44, v108, v109
    v_cvt_pk_bf16_f32 v45, v110, v111
    v_pk_mul_f32 v[112:113], v[210:211], v[112:113] op_sel_hi:[0,1]
    v_pk_mul_f32 v[114:115], v[210:211], v[114:115] op_sel_hi:[0,1]
    v_cvt_pk_bf16_f32 v46, v112, v113
    v_cvt_pk_bf16_f32 v47, v114, v115
    v_pk_mul_f32 v[116:117], v[212:213], v[116:117] op_sel_hi:[0,1]
    v_pk_mul_f32 v[118:119], v[212:213], v[118:119] op_sel_hi:[0,1]
    v_cvt_pk_bf16_f32 v48, v116, v117
    v_cvt_pk_bf16_f32 v49, v118, v119
    v_pk_mul_f32 v[120:121], v[212:213], v[120:121] op_sel_hi:[0,1]
    v_pk_mul_f32 v[122:123], v[212:213], v[122:123] op_sel_hi:[0,1]
    v_cvt_pk_bf16_f32 v50, v120, v121
    v_cvt_pk_bf16_f32 v51, v122, v123
    v_pk_mul_f32 v[124:125], v[214:215], v[124:125] op_sel_hi:[0,1]
    v_pk_mul_f32 v[126:127], v[214:215], v[126:127] op_sel_hi:[0,1]
    v_cvt_pk_bf16_f32 v52, v124, v125
    v_cvt_pk_bf16_f32 v53, v126, v127
    v_pk_mul_f32 v[128:129], v[214:215], v[128:129] op_sel_hi:[0,1]
    v_pk_mul_f32 v[130:131], v[214:215], v[130:131] op_sel_hi:[0,1]
    v_cvt_pk_bf16_f32 v54, v128, v129
    v_cvt_pk_bf16_f32 v55, v130, v131
    v_pk_mul_f32 v[92:93], v[216:217], v[92:93] op_sel_hi:[0,1]
    v_pk_mul_f32 v[94:95], v[216:217], v[94:95] op_sel_hi:[0,1]
    v_cvt_pk_bf16_f32 v56, v92, v93
    v_cvt_pk_bf16_f32 v57, v94, v95
    v_pk_mul_f32 v[96:97], v[218:219], v[96:97] op_sel_hi:[0,1]
    v_pk_mul_f32 v[98:99], v[218:219], v[98:99] op_sel_hi:[0,1]
    v_cvt_pk_bf16_f32 v58, v96, v97
    v_cvt_pk_bf16_f32 v59, v98, v99
    v_pk_mul_f32 v[100:101], v[220:221], v[100:101] op_sel_hi:[0,1]
    v_pk_mul_f32 v[102:103], v[220:221], v[102:103] op_sel_hi:[0,1]
    v_cvt_pk_bf16_f32 v60, v100, v101
    v_cvt_pk_bf16_f32 v61, v102, v103
    v_pk_mul_f32 v[104:105], v[222:223], v[104:105] op_sel_hi:[0,1]
    v_pk_mul_f32 v[106:107], v[222:223], v[106:107] op_sel_hi:[0,1]
    v_cvt_pk_bf16_f32 v62, v104, v105
    v_cvt_pk_bf16_f32 v63, v106, v107
    v_mfma_f32_16x16x32_bf16 v[92:95], v[44:47], v[56:59], v[244:247]
    v_mfma_f32_16x16x32_bf16 v[96:99], v[48:51], v[56:59], v[240:243]
    v_mfma_f32_16x16x32_bf16 v[100:103], v[48:51], v[60:63], v[236:239]
    v_mfma_f32_16x16x32_bf16 v[104:107], v[52:55], v[60:63], v[240:243]
    s_waitcnt lgkmcnt(0)
    v_pk_fma_f32 v[132:133], v[20:21], v[172:173], v[132:133] op_sel_hi:[1,0,1] neg_lo:[1,0,0] neg_hi:[1,0,0]
    v_pk_mul_f32 v[132:133], v[132:133], v[32:33]
    v_pk_fma_f32 v[134:135], v[22:23], v[172:173], v[134:135] op_sel_hi:[1,0,1] neg_lo:[1,0,0] neg_hi:[1,0,0]
    v_pk_mul_f32 v[134:135], v[134:135], v[34:35]
    v_cvt_pk_bf16_f32 v64, v132, v133
    v_cvt_pk_bf16_f32 v65, v134, v135
    v_pk_fma_f32 v[136:137], v[20:21], v[176:177], v[136:137] op_sel_hi:[1,0,1] neg_lo:[1,0,0] neg_hi:[1,0,0]
    v_pk_mul_f32 v[136:137], v[136:137], v[32:33]
    v_pk_fma_f32 v[138:139], v[22:23], v[176:177], v[138:139] op_sel_hi:[1,0,1] neg_lo:[1,0,0] neg_hi:[1,0,0]
    v_pk_mul_f32 v[138:139], v[138:139], v[34:35]
    v_cvt_pk_bf16_f32 v70, v136, v137
    v_cvt_pk_bf16_f32 v71, v138, v139
    v_pk_fma_f32 v[140:141], v[24:25], v[172:173], v[140:141] op_sel_hi:[1,0,1] neg_lo:[1,0,0] neg_hi:[1,0,0]
    v_pk_mul_f32 v[140:141], v[140:141], v[36:37]
    v_pk_fma_f32 v[142:143], v[26:27], v[172:173], v[142:143] op_sel_hi:[1,0,1] neg_lo:[1,0,0] neg_hi:[1,0,0]
    v_pk_mul_f32 v[142:143], v[142:143], v[38:39]
    v_cvt_pk_bf16_f32 v66, v140, v141
    v_cvt_pk_bf16_f32 v67, v142, v143
    v_pk_fma_f32 v[144:145], v[24:25], v[176:177], v[144:145] op_sel_hi:[1,0,1] neg_lo:[1,0,0] neg_hi:[1,0,0]
    v_pk_mul_f32 v[144:145], v[144:145], v[36:37]
    v_pk_fma_f32 v[146:147], v[26:27], v[176:177], v[146:147] op_sel_hi:[1,0,1] neg_lo:[1,0,0] neg_hi:[1,0,0]
    v_pk_mul_f32 v[146:147], v[146:147], v[38:39]
    v_cvt_pk_bf16_f32 v72, v144, v145
    v_cvt_pk_bf16_f32 v73, v146, v147
    v_pk_fma_f32 v[148:149], v[28:29], v[172:173], v[148:149] op_sel_hi:[1,0,1] neg_lo:[1,0,0] neg_hi:[1,0,0]
    v_pk_mul_f32 v[148:149], v[148:149], v[40:41]
    v_pk_fma_f32 v[150:151], v[30:31], v[172:173], v[150:151] op_sel_hi:[1,0,1] neg_lo:[1,0,0] neg_hi:[1,0,0]
    v_pk_mul_f32 v[150:151], v[150:151], v[42:43]
    v_cvt_pk_bf16_f32 v68, v148, v149
    v_cvt_pk_bf16_f32 v69, v150, v151
    v_pk_fma_f32 v[152:153], v[28:29], v[176:177], v[152:153] op_sel_hi:[1,0,1] neg_lo:[1,0,0] neg_hi:[1,0,0]
    v_pk_mul_f32 v[152:153], v[152:153], v[40:41]
    v_pk_fma_f32 v[154:155], v[30:31], v[176:177], v[154:155] op_sel_hi:[1,0,1] neg_lo:[1,0,0] neg_hi:[1,0,0]
    v_pk_mul_f32 v[154:155], v[154:155], v[42:43]
    v_cvt_pk_bf16_f32 v74, v152, v153
    v_cvt_pk_bf16_f32 v75, v154, v155
    v_max3_f32 v216, v92, v93, v94
    v_max3_f32 v220, v100, v101, v102
    v_max3_f32 v216, v216, v95, v96
    v_max3_f32 v220, v220, v103, v104
    v_max3_f32 v216, v216, v97, v98
    v_max3_f32 v220, v220, v105, v106
    v_max_f32 v216, v216, v99
    v_max_f32 v220, v220, v107
    s_nop 1
    v_permlane32_swap_b32 v216, v220
    v_max_f32 v216, v216, v220
    v_mov_b32 v220, v216
    s_nop 1
    v_permlane16_swap_b32 v220, v216
    v_max_f32 v216, v216, v220
    v_mov_b32 v220, v216
    s_nop 1
    v_permlane32_swap_b32 v216, v220
    v_pk_add_f32 v[92:93], v[92:93], v[216:217] op_sel_hi:[1,0] neg_lo:[0,1] neg_hi:[0,1]
    v_pk_add_f32 v[100:101], v[100:101], v[220:221] op_sel_hi:[1,0] neg_lo:[0,1] neg_hi:[0,1]
    v_pk_add_f32 v[94:95], v[94:95], v[216:217] op_sel_hi:[1,0] neg_lo:[0,1] neg_hi:[0,1]
    v_pk_add_f32 v[102:103], v[102:103], v[220:221] op_sel_hi:[1,0] neg_lo:[0,1] neg_hi:[0,1]
    v_pk_add_f32 v[96:97], v[96:97], v[216:217] op_sel_hi:[1,0] neg_lo:[0,1] neg_hi:[0,1]
    v_pk_add_f32 v[104:105], v[104:105], v[220:221] op_sel_hi:[1,0] neg_lo:[0,1] neg_hi:[0,1]
    v_pk_add_f32 v[98:99], v[98:99], v[216:217] op_sel_hi:[1,0] neg_lo:[0,1] neg_hi:[0,1]
    v_pk_add_f32 v[106:107], v[106:107], v[220:221] op_sel_hi:[1,0] neg_lo:[0,1] neg_hi:[0,1]
    v_exp_f32 v92, v92
    v_exp_f32 v100, v100
    v_exp_f32 v93, v93
    v_exp_f32 v101, v101
    v_exp_f32 v94, v94
    v_exp_f32 v102, v102
    v_exp_f32 v95, v95
    v_exp_f32 v103, v103
    v_exp_f32 v96, v96
    v_exp_f32 v104, v104
    v_exp_f32 v97, v97
    v_exp_f32 v105, v105
    v_exp_f32 v98, v98
    v_exp_f32 v106, v106
    v_exp_f32 v99, v99
    v_exp_f32 v107, v107
    v_cvt_pk_bf16_f32 v108, v92, v93
    v_cvt_pk_bf16_f32 v112, v100, v101
    v_cvt_pk_bf16_f32 v109, v94, v95
    v_cvt_pk_bf16_f32 v113, v102, v103
    v_cvt_pk_bf16_f32 v110, v96, v97
    v_cvt_pk_bf16_f32 v114, v104, v105
    v_cvt_pk_bf16_f32 v111, v98, v99
    v_cvt_pk_bf16_f32 v115, v106, v107
    s_nop 0
    v_mfma_f32_16x16x32_bf16 v[116:119], v[64:67], v[108:111], 0
    v_mfma_f32_16x16x32_bf16 v[124:127], v[66:69], v[112:115], 0
    v_mfma_f32_16x16x32_bf16 v[120:123], v[70:73], v[108:111], 0
    v_mfma_f32_16x16x32_bf16 v[128:131], v[72:75], v[112:115], 0
    v_pk_add_f32 v[218:219], v[92:93], v[94:95]
    v_pk_add_f32 v[222:223], v[100:101], v[102:103]
    v_pk_add_f32 v[216:217], v[96:97], v[98:99]
    v_pk_add_f32 v[220:221], v[104:105], v[106:107]
    v_pk_add_f32 v[216:217], v[216:217], v[218:219]
    v_pk_add_f32 v[220:221], v[220:221], v[222:223]
    v_add_f32 v216, v216, v217
    v_add_f32 v220, v220, v221
    s_nop 1
    v_permlane32_swap_b32 v216, v220
    v_add_f32 v216, v216, v220
    v_mov_b32 v220, v216
    s_nop 1
    v_permlane16_swap_b32 v220, v216
    v_add_f32 v216, v216, v220
    v_mov_b32 v220, v216
    s_nop 1
    v_permlane32_swap_b32 v216, v220
    v_rcp_f32 v216, v216
    v_rcp_f32 v220, v220
    v_pk_mul_f32 v[116:117], v[116:117], v[216:217] op_sel_hi:[1,0]
    v_pk_mul_f32 v[118:119], v[118:119], v[216:217] op_sel_hi:[1,0]
    v_pk_mul_f32 v[120:121], v[120:121], v[216:217] op_sel_hi:[1,0]
    v_pk_mul_f32 v[122:123], v[122:123], v[216:217] op_sel_hi:[1,0]
    v_pk_mul_f32 v[124:125], v[124:125], v[220:221] op_sel_hi:[1,0]
    v_pk_mul_f32 v[126:127], v[126:127], v[220:221] op_sel_hi:[1,0]
    v_pk_mul_f32 v[128:129], v[128:129], v[220:221] op_sel_hi:[1,0]
    v_pk_mul_f32 v[130:131], v[130:131], v[220:221] op_sel_hi:[1,0]
    v_cvt_pk_bf16_f32 v76, v116, v117
    v_cvt_pk_bf16_f32 v77, v118, v119
    v_cvt_pk_bf16_f32 v78, v120, v121
    v_cvt_pk_bf16_f32 v79, v122, v123
    v_cndmask_b32 v78, v78, 0, s[64:65]
    v_cndmask_b32 v79, v79, 0, s[64:65]
    v_cvt_pk_bf16_f32 v80, v124, v125
    v_cvt_pk_bf16_f32 v81, v126, v127
    v_cvt_pk_bf16_f32 v82, v128, v129
    v_cvt_pk_bf16_f32 v83, v130, v131
    v_cndmask_b32 v82, v82, 0, s[64:65]
    v_cndmask_b32 v83, v83, 0, s[64:65]
    s_lshl_b32 s36, s32, 3
    s_lshl_b32 s37, s3, 1
    s_add_u32 s36, s36, s37
    s_lshl_b32 s36, s36, 4
    s_add_u32 s36, s36, s39
    s_lshl_b32 s36, s36, 10
    s_add_u32 s36, s36, 4194304
    s_add_u32 s37, s36, 16384
    buffer_store_dwordx4 v[76:79], v10, s[16:19], s36 offen sc1
    buffer_store_dwordx4 v[80:83], v10, s[16:19], s37 offen sc1
    s_lshl_b32 s81, s32, 3
    s_lshl_b32 s37, s34, 2
    s_add_u32 s81, s81, s37
    s_add_u32 s81, s81, s3
    v_and_b32 v13, 15, v1
    s_lshl_b32 s37, s81, 4
    v_add_u32 v13, s37, v13
    s_movk_i32 s38, 896
    v_lshrrev_b32 v14, 4, v1
    v_lshlrev_b32 v14, 3, v14
    v_mad_u32_u24 v13, v13, s38, v14
    s_lshl_b32 s37, s35, 7
    v_add_u32 v13, s37, v13
    buffer_load_dwordx2 v[16:17], v13, s[8:11], 0 offen offset:0
    buffer_load_dwordx2 v[18:19], v13, s[8:11], 0 offen offset:32
    buffer_load_dwordx2 v[20:21], v13, s[8:11], 0 offen offset:64
    buffer_load_dwordx2 v[22:23], v13, s[8:11], 0 offen offset:96
    v_add_u32 v96, 106496, v224
    v_add_u32 v97, 106496, v225
    v_add_u32 v98, 106496, v226
    v_add_u32 v99, 106496, v227
    v_mov_b32 v15, 0
    v_cndmask_b32 v15, v15, 1.0, s[64:65]
    v_cvt_u32_f32 v15, v15
    v_lshlrev_b32 v15, 10, v15
    s_waitcnt vmcnt(7)
    s_barrier
    ds_read_b64_tr_b16 a[0:1], v96 offset:0
    ds_read_b64_tr_b16 a[4:5], v97 offset:0
    ds_read_b64_tr_b16 a[8:9], v98 offset:0
    ds_read_b64_tr_b16 a[12:13], v99 offset:0
    ds_read_b64_tr_b16 a[2:3], v96 offset:2048
    ds_read_b64_tr_b16 a[6:7], v97 offset:2048
    ds_read_b64_tr_b16 a[10:11], v98 offset:2048
    ds_read_b64_tr_b16 a[14:15], v99 offset:2048
    ds_read_b64_tr_b16 a[16:17], v98 offset:3584
    ds_read_b64_tr_b16 a[20:21], v99 offset:3584
    ds_read_b64_tr_b16 a[24:25], v96 offset:3584
    ds_read_b64_tr_b16 a[28:29], v97 offset:3584
    ds_read_b64_tr_b16 a[18:19], v98 offset:5632
    ds_read_b64_tr_b16 a[22:23], v99 offset:5632
    ds_read_b64_tr_b16 a[26:27], v96 offset:5632
    ds_read_b64_tr_b16 a[30:31], v97 offset:5632
    ds_read_b64_tr_b16 a[32:33], v96 offset:7168
    ds_read_b64_tr_b16 a[36:37], v97 offset:7168
    ds_read_b64_tr_b16 a[40:41], v98 offset:7168
    ds_read_b64_tr_b16 a[44:45], v99 offset:7168
    ds_read_b64_tr_b16 a[34:35], v96 offset:9216
    ds_read_b64_tr_b16 a[38:39], v97 offset:9216
    ds_read_b64_tr_b16 a[42:43], v98 offset:9216
    ds_read_b64_tr_b16 a[46:47], v99 offset:9216
    ds_read_b64_tr_b16 a[48:49], v98 offset:10752
    ds_read_b64_tr_b16 a[52:53], v99 offset:10752
    ds_read_b64_tr_b16 a[56:57], v96 offset:10752
    ds_read_b64_tr_b16 a[60:61], v97 offset:10752
    ds_read_b64_tr_b16 a[50:51], v98 offset:12800
    ds_read_b64_tr_b16 a[54:55], v99 offset:12800
    ds_read_b64_tr_b16 a[58:59], v96 offset:12800
    ds_read_b64_tr_b16 a[62:63], v97 offset:12800
    ds_read_b64_tr_b16 a[64:65], v96 offset:14336
    ds_read_b64_tr_b16 a[68:69], v97 offset:14336
    ds_read_b64_tr_b16 a[72:73], v98 offset:14336
    ds_read_b64_tr_b16 a[76:77], v99 offset:14336
    ds_read_b64_tr_b16 a[66:67], v96 offset:16384
    ds_read_b64_tr_b16 a[70:71], v97 offset:16384
    ds_read_b64_tr_b16 a[74:75], v98 offset:16384
    ds_read_b64_tr_b16 a[78:79], v99 offset:16384
    s_waitcnt vmcnt(4)
    s_barrier
    s_cmp_lg_u32 s3, 0
    s_cbranch_scc1 OW_8
    s_lshl_b32 s36, s32, 9
    s_lshl_b32 s37, s39, 2
    s_add_u32 s36, s36, s37
    s_add_u32 s36, s36, 8323072
    v_mov_b32 v13, 0
    v_mov_b32 v14, 1
    s_mov_b64 exec, 1
    buffer_store_dword v14, v13, s[16:19], s36 offen sc1
    s_mov_b64 exec, -1
OW_8:
    s_cmp_eq_u32 s35, 7
    s_cbranch_scc1 K_pf
    s_waitcnt vmcnt(0)
    v_lshlrev_b32 v132, 16, v16
    v_and_b32 v133, 0xffff0000, v16
    v_lshlrev_b32 v134, 16, v17
    v_and_b32 v135, 0xffff0000, v17
    v_lshlrev_b32 v136, 16, v18
    v_and_b32 v137, 0xffff0000, v18
    v_lshlrev_b32 v138, 16, v19
    v_and_b32 v139, 0xffff0000, v19
    v_lshlrev_b32 v140, 16, v20
    v_and_b32 v141, 0xffff0000, v20
    v_lshlrev_b32 v142, 16, v21
    v_and_b32 v143, 0xffff0000, v21
    v_lshlrev_b32 v144, 16, v22
    v_and_b32 v145, 0xffff0000, v22
    v_lshlrev_b32 v146, 16, v23
    v_and_b32 v147, 0xffff0000, v23
    s_cmp_eq_u32 s3, 0
    s_cbranch_scc1 X1p_9
    s_sub_u32 s36, s3, 1
    s_add_u32 s36, s36, 0
    s_lshl_b32 s82, s36, 10
    s_mul_i32 s83, s36, 14336
    s_lshl_b32 s37, s33, 8
    s_add_u32 s83, s83, s37
    v_xor_b32 v251, 32, v253
    ds_read_b64_tr_b16 a[80:81], v98 offset:17920
    s_add_u32 m0, s82, 0
    s_add_u32 s46, s83, 0
    buffer_load_dwordx4 v251, s[24:27], s46 offen lds
    s_mul_i32 s36, s3, 7
    ds_read_b64_tr_b16 a[84:85], v99 offset:17920
    s_add_u32 s36, s36, 0
    ds_read_b64_tr_b16 a[88:89], v96 offset:17920
    s_lshr_b32 s37, s36, 1
    s_add_u32 m0, s82, 3072
    s_add_u32 s46, s83, 43008
    buffer_load_dwordx4 v253, s[24:27], s46 offen lds
    ds_read_b64_tr_b16 a[92:93], v97 offset:17920
    s_lshl_b32 s37, s37, 2
    ds_read_b64_tr_b16 a[82:83], v98 offset:19968
    s_and_b32 s36, s36, 1
    ds_read_b64_tr_b16 a[86:87], v99 offset:19968
    s_add_u32 m0, s82, 6144
    s_add_u32 s46, s83, 86016
    buffer_load_dwordx4 v251, s[24:27], s46 offen lds
    s_add_u32 s37, s37, s36
    ds_read_b64_tr_b16 a[90:91], v96 offset:19968
    s_add_u32 s50, s37, 0
    ds_read_b64_tr_b16 a[94:95], v97 offset:19968
    s_mul_i32 s36, s3, 7
    s_add_u32 m0, s82, 9216
    s_add_u32 s46, s83, 129024
    buffer_load_dwordx4 v253, s[24:27], s46 offen lds
    ds_read_b64_tr_b16 a[96:97], v96 offset:21504
    s_add_u32 s36, s36, 1
    ds_read_b64_tr_b16 a[100:101], v97 offset:21504
    s_lshr_b32 s37, s36, 1
    ds_read_b64_tr_b16 a[104:105], v98 offset:21504
    s_add_u32 m0, s82, 12288
    s_add_u32 s46, s83, 172032
    buffer_load_dwordx4 v251, s[24:27], s46 offen lds
    s_lshl_b32 s37, s37, 2
    ds_read_b64_tr_b16 a[108:109], v99 offset:21504
    s_and_b32 s36, s36, 1
    ds_read_b64_tr_b16 a[98:99], v96 offset:23552
    s_add_u32 s37, s37, s36
    s_add_u32 m0, s82, 15360
    s_add_u32 s46, s83, 215040
    buffer_load_dwordx4 v253, s[24:27], s46 offen lds
    ds_read_b64_tr_b16 a[102:103], v97 offset:23552
    s_add_u32 s51, s37, 0
    ds_read_b64_tr_b16 a[106:107], v98 offset:23552
    s_mul_i32 s36, s3, 7
    ds_read_b64_tr_b16 a[110:111], v99 offset:23552
    s_add_u32 m0, s82, 18432
    s_add_u32 s46, s83, 258048
    buffer_load_dwordx4 v251, s[24:27], s46 offen lds
    s_add_u32 s36, s36, 2
    ds_read_b64_tr_b16 a[112:113], v98 offset:25088
    s_lshr_b32 s37, s36, 1
    ds_read_b64_tr_b16 a[116:117], v99 offset:25088
    s_lshl_b32 s37, s37, 2
    s_add_u32 m0, s82, 21504
    s_add_u32 s46, s83, 301056
    buffer_load_dwordx4 v253, s[24:27], s46 offen lds
    ds_read_b64_tr_b16 a[120:121], v96 offset:25088
    s_and_b32 s36, s36, 1
    ds_read_b64_tr_b16 a[124:125], v97 offset:25088
    s_add_u32 s37, s37, s36
    ds_read_b64_tr_b16 a[114:115], v98 offset:27136
    s_add_u32 m0, s82, 24576
    s_add_u32 s46, s83, 344064
    buffer_load_dwordx4 v251, s[24:27], s46 offen lds
    s_add_u32 s52, s37, 0
    ds_read_b64_tr_b16 a[118:119], v99 offset:27136
    s_mul_i32 s36, s3, 7
    ds_read_b64_tr_b16 a[122:123], v96 offset:27136
    s_add_u32 s36, s36, 3
    s_add_u32 m0, s82, 27648
    s_add_u32 s46, s83, 387072
    buffer_load_dwordx4 v253, s[24:27], s46 offen lds
    ds_read_b64_tr_b16 a[126:127], v97 offset:27136
    s_lshr_b32 s37, s36, 1
    ds_read_b64_tr_b16 a[128:129], v96 offset:28672
    s_lshl_b32 s37, s37, 2
    ds_read_b64_tr_b16 a[132:133], v97 offset:28672
    s_add_u32 m0, s82, 30720
    s_add_u32 s46, s83, 430080
    buffer_load_dwordx4 v251, s[24:27], s46 offen lds
    s_and_b32 s36, s36, 1
    ds_read_b64_tr_b16 a[136:137], v98 offset:28672
    s_add_u32 s37, s37, s36
    ds_read_b64_tr_b16 a[140:141], v99 offset:28672
    s_add_u32 s53, s37, 0
    s_add_u32 m0, s82, 33792
    s_add_u32 s46, s83, 473088
    buffer_load_dwordx4 v253, s[24:27], s46 offen lds
    ds_read_b64_tr_b16 a[130:131], v96 offset:30720
    s_mul_i32 s36, s3, 7
    ds_read_b64_tr_b16 a[134:135], v97 offset:30720
    s_add_u32 s36, s36, 4
    ds_read_b64_tr_b16 a[138:139], v98 offset:30720
    s_add_u32 m0, s82, 36864
    s_add_u32 s46, s83, 516096
    buffer_load_dwordx4 v251, s[24:27], s46 offen lds
    s_lshr_b32 s37, s36, 1
    ds_read_b64_tr_b16 a[142:143], v99 offset:30720
    s_lshl_b32 s37, s37, 2
    ds_read_b64_tr_b16 a[144:145], v98 offset:32256
    s_and_b32 s36, s36, 1
    s_add_u32 m0, s82, 39936
    s_add_u32 s46, s83, 559104
    buffer_load_dwordx4 v253, s[24:27], s46 offen lds
    ds_read_b64_tr_b16 a[148:149], v99 offset:32256
    s_add_u32 s37, s37, s36
    ds_read_b64_tr_b16 a[152:153], v96 offset:32256
    s_add_u32 s54, s37, 0
    ds_read_b64_tr_b16 a[156:157], v97 offset:32256
    s_add_u32 m0, s82, 43008
    s_add_u32 s46, s83, 602112
    buffer_load_dwordx4 v251, s[24:27], s46 offen lds
    s_mul_i32 s36, s3, 7
    ds_read_b64_tr_b16 a[146:147], v98 offset:34304
    s_add_u32 s36, s36, 5
    ds_read_b64_tr_b16 a[150:151], v99 offset:34304
    s_lshr_b32 s37, s36, 1
    s_add_u32 m0, s82, 46080
    s_add_u32 s46, s83, 645120
    buffer_load_dwordx4 v253, s[24:27], s46 offen lds
    ds_read_b64_tr_b16 a[154:155], v96 offset:34304
    s_lshl_b32 s37, s37, 2
    ds_read_b64_tr_b16 a[158:159], v97 offset:34304
    s_and_b32 s36, s36, 1
    ds_read_b64_tr_b16 a[160:161], v96 offset:35840
    s_add_u32 m0, s82, 49152
    s_add_u32 s46, s83, 688128
    buffer_load_dwordx4 v251, s[24:27], s46 offen lds
    s_add_u32 s37, s37, s36
    ds_read_b64_tr_b16 a[164:165], v97 offset:35840
    s_add_u32 s55, s37, 0
    ds_read_b64_tr_b16 a[168:169], v98 offset:35840
    s_mul_i32 s36, s3, 7
    s_add_u32 m0, s82, 52224
    s_add_u32 s46, s83, 731136
    buffer_load_dwordx4 v253, s[24:27], s46 offen lds
    ds_read_b64_tr_b16 a[172:173], v99 offset:35840
    s_add_u32 s36, s36, 6
    ds_read_b64_tr_b16 a[162:163], v96 offset:37888
    s_lshr_b32 s37, s36, 1
    ds_read_b64_tr_b16 a[166:167], v97 offset:37888
    s_add_u32 m0, s82, 55296
    s_add_u32 s46, s83, 774144
    buffer_load_dwordx4 v251, s[24:27], s46 offen lds
    s_lshl_b32 s37, s37, 2
    ds_read_b64_tr_b16 a[170:171], v98 offset:37888
    s_and_b32 s36, s36, 1
    ds_read_b64_tr_b16 a[174:175], v99 offset:37888
    s_add_u32 s37, s37, s36
    s_add_u32 m0, s82, 58368
    s_add_u32 s46, s83, 817152
    buffer_load_dwordx4 v253, s[24:27], s46 offen lds
    ds_read_b64_tr_b16 a[176:177], v98 offset:39424
    s_add_u32 s56, s37, 0
    ds_read_b64_tr_b16 a[180:181], v99 offset:39424
    s_mul_i32 s36, s3, 7
    ds_read_b64_tr_b16 a[184:185], v96 offset:39424
    s_add_u32 m0, s82, 61440
    s_add_u32 s46, s83, 860160
    buffer_load_dwordx4 v251, s[24:27], s46 offen lds
    s_add_u32 s36, s36, 0
    ds_read_b64_tr_b16 a[188:189], v97 offset:39424
    s_lshr_b32 s37, s36, 1
    ds_read_b64_tr_b16 a[178:179], v98 offset:41472
    s_lshl_b32 s37, s37, 2
    s_add_u32 m0, s82, 64512
    s_add_u32 s46, s83, 903168
    buffer_load_dwordx4 v253, s[24:27], s46 offen lds
    ds_read_b64_tr_b16 a[182:183], v99 offset:41472
    s_and_b32 s36, s36, 1
    ds_read_b64_tr_b16 a[186:187], v96 offset:41472
    s_add_u32 s37, s37, s36
    ds_read_b64_tr_b16 a[190:191], v97 offset:41472
    s_add_u32 m0, s82, 67584
    s_add_u32 s46, s83, 946176
    buffer_load_dwordx4 v251, s[24:27], s46 offen lds
    s_add_u32 s57, s37, 2
    ds_read_b64_tr_b16 a[192:193], v96 offset:43008
    s_mul_i32 s36, s3, 7
    ds_read_b64_tr_b16 a[196:197], v97 offset:43008
    s_add_u32 s36, s36, 1
    s_add_u32 m0, s82, 70656
    s_add_u32 s46, s83, 989184
    buffer_load_dwordx4 v253, s[24:27], s46 offen lds
    ds_read_b64_tr_b16 a[200:201], v98 offset:43008
    s_lshr_b32 s37, s36, 1
    ds_read_b64_tr_b16 a[204:205], v99 offset:43008
    s_lshl_b32 s37, s37, 2
    ds_read_b64_tr_b16 a[194:195], v96 offset:45056
    s_add_u32 m0, s82, 73728
    s_add_u32 s46, s83, 1032192
    buffer_load_dwordx4 v251, s[24:27], s46 offen lds
    s_and_b32 s36, s36, 1
    ds_read_b64_tr_b16 a[198:199], v97 offset:45056
    s_add_u32 s37, s37, s36
    ds_read_b64_tr_b16 a[202:203], v98 offset:45056
    s_add_u32 s58, s37, 2
    s_add_u32 m0, s82, 76800
    s_add_u32 s46, s83, 1075200
    buffer_load_dwordx4 v253, s[24:27], s46 offen lds
    ds_read_b64_tr_b16 a[206:207], v99 offset:45056
    s_mul_i32 s36, s3, 7
    ds_read_b64_tr_b16 a[208:209], v98 offset:46592
    s_add_u32 s36, s36, 2
    ds_read_b64_tr_b16 a[212:213], v99 offset:46592
    s_add_u32 m0, s82, 79872
    s_add_u32 s46, s83, 1118208
    buffer_load_dwordx4 v251, s[24:27], s46 offen lds
    s_lshr_b32 s37, s36, 1
    ds_read_b64_tr_b16 a[216:217], v96 offset:46592
    s_lshl_b32 s37, s37, 2
    ds_read_b64_tr_b16 a[220:221], v97 offset:46592
    s_and_b32 s36, s36, 1
    s_add_u32 m0, s82, 82944
    s_add_u32 s46, s83, 1161216
    buffer_load_dwordx4 v253, s[24:27], s46 offen lds
    ds_read_b64_tr_b16 a[210:211], v98 offset:48640
    s_add_u32 s37, s37, s36
    ds_read_b64_tr_b16 a[214:215], v99 offset:48640
    s_add_u32 s59, s37, 2
    ds_read_b64_tr_b16 a[218:219], v96 offset:48640
    s_add_u32 m0, s82, 86016
    s_add_u32 s46, s83, 1204224
    buffer_load_dwordx4 v251, s[24:27], s46 offen lds
    s_mul_i32 s36, s3, 7
    ds_read_b64_tr_b16 a[222:223], v97 offset:48640
    s_add_u32 s36, s36, 3
    ds_read_b64_tr_b16 a[224:225], v96 offset:50176
    s_lshr_b32 s37, s36, 1
    s_add_u32 m0, s82, 89088
    s_add_u32 s46, s83, 1247232
    buffer_load_dwordx4 v253, s[24:27], s46 offen lds
    ds_read_b64_tr_b16 a[228:229], v97 offset:50176
    s_lshl_b32 s37, s37, 2
    ds_read_b64_tr_b16 a[232:233], v98 offset:50176
    s_and_b32 s36, s36, 1
    ds_read_b64_tr_b16 a[236:237], v99 offset:50176
    s_add_u32 m0, s82, 92160
    s_add_u32 s46, s83, 1290240
    buffer_load_dwordx4 v251, s[24:27], s46 offen lds
    s_add_u32 s37, s37, s36
    ds_read_b64_tr_b16 a[226:227], v96 offset:52224
    s_add_u32 s60, s37, 2
    ds_read_b64_tr_b16 a[230:231], v97 offset:52224
    s_mul_i32 s36, s3, 7
    s_add_u32 m0, s82, 95232
    s_add_u32 s46, s83, 1333248
    buffer_load_dwordx4 v253, s[24:27], s46 offen lds
    ds_read_b64_tr_b16 a[234:235], v98 offset:52224
    s_add_u32 s36, s36, 4
    ds_read_b64_tr_b16 a[238:239], v99 offset:52224
    s_lshr_b32 s37, s36, 1
    ds_read_b64_tr_b16 a[240:241], v98 offset:53760
    s_add_u32 m0, s82, 98304
    s_add_u32 s46, s83, 1376256
    buffer_load_dwordx4 v251, s[24:27], s46 offen lds
    s_lshl_b32 s37, s37, 2
    ds_read_b64_tr_b16 a[244:245], v99 offset:53760
    s_and_b32 s36, s36, 1
    ds_read_b64_tr_b16 a[248:249], v96 offset:53760
    s_add_u32 s37, s37, s36
    s_add_u32 m0, s82, 101376
    s_add_u32 s46, s83, 1419264
    buffer_load_dwordx4 v253, s[24:27], s46 offen lds
    ds_read_b64_tr_b16 a[252:253], v97 offset:53760
    s_add_u32 s61, s37, 2
    v_sub_u32 v96, v96, v15
    s_mul_i32 s36, s3, 7
    v_sub_u32 v97, v97, v15
    s_cmp_gt_u32 s3, 2
    s_cbranch_scc1 W1s_11
    s_add_u32 m0, s82, 104448
    s_add_u32 s46, s83, 1462272
    buffer_load_dwordx4 v251, s[24:27], s46 offen lds
W1s_11:
    s_add_u32 s36, s36, 5
    v_sub_u32 v98, v98, v15
    s_lshr_b32 s37, s36, 1
    v_sub_u32 v99, v99, v15
    s_lshl_b32 s37, s37, 2
    ds_read_b64_tr_b16 a[242:243], v98 offset:55808
    s_and_b32 s36, s36, 1
    ds_read_b64_tr_b16 a[246:247], v99 offset:55808
    s_add_u32 s37, s37, s36
    ds_read_b64_tr_b16 a[250:251], v96 offset:55808
    s_add_u32 s62, s37, 2
    ds_read_b64_tr_b16 a[254:255], v97 offset:55808
    s_mul_i32 s36, s3, 7
    s_add_u32 s36, s36, 6
    s_lshr_b32 s37, s36, 1
    s_lshl_b32 s37, s37, 2
    s_and_b32 s36, s36, 1
    s_add_u32 s37, s37, s36
    s_add_u32 s63, s37, 2
    s_mov_b32 s40, s81
    s_lshl_b32 s41, s40, 14
    s_add_u32 s41, s41, 4194304
    s_mul_i32 s74, s3, 12288
    s_add_u32 s74, s74, 114688
    s_lshl_b32 s75, s35, 7
    s_lshl_b32 s80, s3, 10
    v_bfe_u32 v13, v1, 2, 2
    v_lshrrev_b32 v14, 5, v1
    v_lshl_add_u32 v12, v14, 2, v13
    v_lshlrev_b32 v12, 8, v12
    v_lshl_add_u32 v13, v13, 1, v14
    v_bfe_u32 v14, v1, 4, 1
    v_xor_b32 v13, v13, v14
    v_lshl_add_u32 v12, v13, 5, v12
    v_and_b32 v13, 3, v1
    v_lshl_add_u32 v232, v13, 3, v12
    v_xor_b32 v233, 64, v232
    v_xor_b32 v234, 128, v232
    v_xor_b32 v235, 192, v232
    s_waitcnt lgkmcnt(0)
    s_branch X1j_10
X1p_9:
    ds_read_b64_tr_b16 a[80:81], v98 offset:17920
    s_mul_i32 s36, s3, 7
    ds_read_b64_tr_b16 a[84:85], v99 offset:17920
    s_add_u32 s36, s36, 0
    ds_read_b64_tr_b16 a[88:89], v96 offset:17920
    s_lshr_b32 s37, s36, 1
    ds_read_b64_tr_b16 a[92:93], v97 offset:17920
    s_lshl_b32 s37, s37, 2
    ds_read_b64_tr_b16 a[82:83], v98 offset:19968
    s_and_b32 s36, s36, 1
    ds_read_b64_tr_b16 a[86:87], v99 offset:19968
    s_add_u32 s37, s37, s36
    ds_read_b64_tr_b16 a[90:91], v96 offset:19968
    s_add_u32 s50, s37, 0
    ds_read_b64_tr_b16 a[94:95], v97 offset:19968
    s_mul_i32 s36, s3, 7
    ds_read_b64_tr_b16 a[96:97], v96 offset:21504
    s_add_u32 s36, s36, 1
    ds_read_b64_tr_b16 a[100:101], v97 offset:21504
    s_lshr_b32 s37, s36, 1
    ds_read_b64_tr_b16 a[104:105], v98 offset:21504
    s_lshl_b32 s37, s37, 2
    ds_read_b64_tr_b16 a[108:109], v99 offset:21504
    s_and_b32 s36, s36, 1
    ds_read_b64_tr_b16 a[98:99], v96 offset:23552
    s_add_u32 s37, s37, s36
    ds_read_b64_tr_b16 a[102:103], v97 offset:23552
    s_add_u32 s51, s37, 0
    ds_read_b64_tr_b16 a[106:107], v98 offset:23552
    s_mul_i32 s36, s3, 7
    ds_read_b64_tr_b16 a[110:111], v99 offset:23552
    s_add_u32 s36, s36, 2
    ds_read_b64_tr_b16 a[112:113], v98 offset:25088
    s_lshr_b32 s37, s36, 1
    ds_read_b64_tr_b16 a[116:117], v99 offset:25088
    s_lshl_b32 s37, s37, 2
    ds_read_b64_tr_b16 a[120:121], v96 offset:25088
    s_and_b32 s36, s36, 1
    ds_read_b64_tr_b16 a[124:125], v97 offset:25088
    s_add_u32 s37, s37, s36
    ds_read_b64_tr_b16 a[114:115], v98 offset:27136
    s_add_u32 s52, s37, 0
    ds_read_b64_tr_b16 a[118:119], v99 offset:27136
    s_mul_i32 s36, s3, 7
    ds_read_b64_tr_b16 a[122:123], v96 offset:27136
    s_add_u32 s36, s36, 3
    ds_read_b64_tr_b16 a[126:127], v97 offset:27136
    s_lshr_b32 s37, s36, 1
    ds_read_b64_tr_b16 a[128:129], v96 offset:28672
    s_lshl_b32 s37, s37, 2
    ds_read_b64_tr_b16 a[132:133], v97 offset:28672
    s_and_b32 s36, s36, 1
    ds_read_b64_tr_b16 a[136:137], v98 offset:28672
    s_add_u32 s37, s37, s36
    ds_read_b64_tr_b16 a[140:141], v99 offset:28672
    s_add_u32 s53, s37, 0
    ds_read_b64_tr_b16 a[130:131], v96 offset:30720
    s_mul_i32 s36, s3, 7
    ds_read_b64_tr_b16 a[134:135], v97 offset:30720
    s_add_u32 s36, s36, 4
    ds_read_b64_tr_b16 a[138:139], v98 offset:30720
    s_lshr_b32 s37, s36, 1
    ds_read_b64_tr_b16 a[142:143], v99 offset:30720
    s_lshl_b32 s37, s37, 2
    ds_read_b64_tr_b16 a[144:145], v98 offset:32256
    s_and_b32 s36, s36, 1
    ds_read_b64_tr_b16 a[148:149], v99 offset:32256
    s_add_u32 s37, s37, s36
    ds_read_b64_tr_b16 a[152:153], v96 offset:32256
    s_add_u32 s54, s37, 0
    ds_read_b64_tr_b16 a[156:157], v97 offset:32256
    s_mul_i32 s36, s3, 7
    ds_read_b64_tr_b16 a[146:147], v98 offset:34304
    s_add_u32 s36, s36, 5
    ds_read_b64_tr_b16 a[150:151], v99 offset:34304
    s_lshr_b32 s37, s36, 1
    ds_read_b64_tr_b16 a[154:155], v96 offset:34304
    s_lshl_b32 s37, s37, 2
    ds_read_b64_tr_b16 a[158:159], v97 offset:34304
    s_and_b32 s36, s36, 1
    ds_read_b64_tr_b16 a[160:161], v96 offset:35840
    s_add_u32 s37, s37, s36
    ds_read_b64_tr_b16 a[164:165], v97 offset:35840
    s_add_u32 s55, s37, 0
    ds_read_b64_tr_b16 a[168:169], v98 offset:35840
    s_mul_i32 s36, s3, 7
    ds_read_b64_tr_b16 a[172:173], v99 offset:35840
    s_add_u32 s36, s36, 6
    ds_read_b64_tr_b16 a[162:163], v96 offset:37888
    s_lshr_b32 s37, s36, 1
    ds_read_b64_tr_b16 a[166:167], v97 offset:37888
    s_lshl_b32 s37, s37, 2
    ds_read_b64_tr_b16 a[170:171], v98 offset:37888
    s_and_b32 s36, s36, 1
    ds_read_b64_tr_b16 a[174:175], v99 offset:37888
    s_add_u32 s37, s37, s36
    ds_read_b64_tr_b16 a[176:177], v98 offset:39424
    s_add_u32 s56, s37, 0
    ds_read_b64_tr_b16 a[180:181], v99 offset:39424
    s_mul_i32 s36, s3, 7
    ds_read_b64_tr_b16 a[184:185], v96 offset:39424
    s_add_u32 s36, s36, 0
    ds_read_b64_tr_b16 a[188:189], v97 offset:39424
    s_lshr_b32 s37, s36, 1
    ds_read_b64_tr_b16 a[178:179], v98 offset:41472
    s_lshl_b32 s37, s37, 2
    ds_read_b64_tr_b16 a[182:183], v99 offset:41472
    s_and_b32 s36, s36, 1
    ds_read_b64_tr_b16 a[186:187], v96 offset:41472
    s_add_u32 s37, s37, s36
    ds_read_b64_tr_b16 a[190:191], v97 offset:41472
    s_add_u32 s57, s37, 2
    ds_read_b64_tr_b16 a[192:193], v96 offset:43008
    s_mul_i32 s36, s3, 7
    ds_read_b64_tr_b16 a[196:197], v97 offset:43008
    s_add_u32 s36, s36, 1
    ds_read_b64_tr_b16 a[200:201], v98 offset:43008
    s_lshr_b32 s37, s36, 1
    ds_read_b64_tr_b16 a[204:205], v99 offset:43008
    s_lshl_b32 s37, s37, 2
    ds_read_b64_tr_b16 a[194:195], v96 offset:45056
    s_and_b32 s36, s36, 1
    ds_read_b64_tr_b16 a[198:199], v97 offset:45056
    s_add_u32 s37, s37, s36
    ds_read_b64_tr_b16 a[202:203], v98 offset:45056
    s_add_u32 s58, s37, 2
    ds_read_b64_tr_b16 a[206:207], v99 offset:45056
    s_mul_i32 s36, s3, 7
    ds_read_b64_tr_b16 a[208:209], v98 offset:46592
    s_add_u32 s36, s36, 2
    ds_read_b64_tr_b16 a[212:213], v99 offset:46592
    s_lshr_b32 s37, s36, 1
    ds_read_b64_tr_b16 a[216:217], v96 offset:46592
    s_lshl_b32 s37, s37, 2
    ds_read_b64_tr_b16 a[220:221], v97 offset:46592
    s_and_b32 s36, s36, 1
    ds_read_b64_tr_b16 a[210:211], v98 offset:48640
    s_add_u32 s37, s37, s36
    ds_read_b64_tr_b16 a[214:215], v99 offset:48640
    s_add_u32 s59, s37, 2
    ds_read_b64_tr_b16 a[218:219], v96 offset:48640
    s_mul_i32 s36, s3, 7
    ds_read_b64_tr_b16 a[222:223], v97 offset:48640
    s_add_u32 s36, s36, 3
    ds_read_b64_tr_b16 a[224:225], v96 offset:50176
    s_lshr_b32 s37, s36, 1
    ds_read_b64_tr_b16 a[228:229], v97 offset:50176
    s_lshl_b32 s37, s37, 2
    ds_read_b64_tr_b16 a[232:233], v98 offset:50176
    s_and_b32 s36, s36, 1
    ds_read_b64_tr_b16 a[236:237], v99 offset:50176
    s_add_u32 s37, s37, s36
    ds_read_b64_tr_b16 a[226:227], v96 offset:52224
    s_add_u32 s60, s37, 2
    ds_read_b64_tr_b16 a[230:231], v97 offset:52224
    s_mul_i32 s36, s3, 7
    ds_read_b64_tr_b16 a[234:235], v98 offset:52224
    s_add_u32 s36, s36, 4
    ds_read_b64_tr_b16 a[238:239], v99 offset:52224
    s_lshr_b32 s37, s36, 1
    ds_read_b64_tr_b16 a[240:241], v98 offset:53760
    s_lshl_b32 s37, s37, 2
    ds_read_b64_tr_b16 a[244:245], v99 offset:53760
    s_and_b32 s36, s36, 1
    ds_read_b64_tr_b16 a[248:249], v96 offset:53760
    s_add_u32 s37, s37, s36
    ds_read_b64_tr_b16 a[252:253], v97 offset:53760
    s_add_u32 s61, s37, 2
    v_sub_u32 v96, v96, v15
    s_mul_i32 s36, s3, 7
    v_sub_u32 v97, v97, v15
    s_add_u32 s36, s36, 5
    v_sub_u32 v98, v98, v15
    s_lshr_b32 s37, s36, 1
    v_sub_u32 v99, v99, v15
    s_lshl_b32 s37, s37, 2
    ds_read_b64_tr_b16 a[242:243], v98 offset:55808
    s_and_b32 s36, s36, 1
    ds_read_b64_tr_b16 a[246:247], v99 offset:55808
    s_add_u32 s37, s37, s36
    ds_read_b64_tr_b16 a[250:251], v96 offset:55808
    s_add_u32 s62, s37, 2
    ds_read_b64_tr_b16 a[254:255], v97 offset:55808
    s_mul_i32 s36, s3, 7
    s_add_u32 s36, s36, 6
    s_lshr_b32 s37, s36, 1
    s_lshl_b32 s37, s37, 2
    s_and_b32 s36, s36, 1
    s_add_u32 s37, s37, s36
    s_add_u32 s63, s37, 2
    s_mov_b32 s40, s81
    s_lshl_b32 s41, s40, 14
    s_add_u32 s41, s41, 4194304
    s_mul_i32 s74, s3, 12288
    s_add_u32 s74, s74, 114688
    s_lshl_b32 s75, s35, 7
    s_lshl_b32 s80, s3, 10
    v_bfe_u32 v13, v1, 2, 2
    v_lshrrev_b32 v14, 5, v1
    v_lshl_add_u32 v12, v14, 2, v13
    v_lshlrev_b32 v12, 8, v12
    v_lshl_add_u32 v13, v13, 1, v14
    v_bfe_u32 v14, v1, 4, 1
    v_xor_b32 v13, v13, v14
    v_lshl_add_u32 v12, v13, 5, v12
    v_and_b32 v13, 3, v1
    v_lshl_add_u32 v232, v13, 3, v12
    v_xor_b32 v233, 64, v232
    v_xor_b32 v234, 128, v232
    v_xor_b32 v235, 192, v232
    s_cmp_lg_u32 s3, 0
    s_cbranch_scc1 OW_12
    v_min_u32 v2, 15, v1
    v_lshlrev_b32 v2, 2, v2
    s_lshl_b32 s47, s32, 9
    s_add_u32 s47, s47, 8323072
    s_waitcnt vmcnt(0)
    buffer_load_dword v0, v2, s[16:19], s47 offen sc1
    s_mov_b32 s38, 0
PLl_13:
    s_sleep 2
    buffer_load_dword v254, v2, s[16:19], s47 offen sc1
    s_waitcnt vmcnt(1)
    v_cmp_ne_u32 vcc, 1, v0
    s_cbranch_vccz PLk_14
    s_sleep 2
    buffer_load_dword v0, v2, s[16:19], s47 offen sc1
    s_waitcnt vmcnt(1)
    v_cmp_ne_u32 vcc, 1, v254
    s_cbranch_vccz PLk_14
    s_add_u32 s38, s38, 1
    s_cmp_lt_u32 s38, 300000
    s_cbranch_scc1 PLl_13
PLk_14:
OW_12:
    s_waitcnt lgkmcnt(0)
X1j_10:
    s_barrier
    s_add_u32 s37, s41, 0
    buffer_load_dwordx4 v[32:35], v10, s[16:19], s37 offen offset:0 sc1
    buffer_load_dwordx4 v[36:39], v10, s[16:19], s37 offen offset:1024 sc1
    buffer_load_dwordx4 v[40:43], v10, s[16:19], s37 offen offset:2048 sc1
    buffer_load_dwordx4 v[44:47], v10, s[16:19], s37 offen offset:3072 sc1
    s_add_u32 s37, s41, 4096
    buffer_load_dwordx4 v[48:51], v10, s[16:19], s37 offen offset:0 sc1
    buffer_load_dwordx4 v[52:55], v10, s[16:19], s37 offen offset:1024 sc1
    buffer_load_dwordx4 v[56:59], v10, s[16:19], s37 offen offset:2048 sc1
    buffer_load_dwordx4 v[60:63], v10, s[16:19], s37 offen offset:3072 sc1
    s_add_u32 s37, s41, 8192
    buffer_load_dwordx4 v[64:67], v10, s[16:19], s37 offen offset:0 sc1
    buffer_load_dwordx4 v[68:71], v10, s[16:19], s37 offen offset:1024 sc1
    buffer_load_dwordx4 v[72:75], v10, s[16:19], s37 offen offset:2048 sc1
    s_lshl_b32 s42, s33, 8
    s_mul_i32 s43, s3, 14336
    s_add_u32 s43, s43, s42
    s_add_u32 m0, s80, 106496
    s_add_u32 s46, s43, 1490944
    buffer_load_dwordx4 v253, s[24:27], s46 offen lds
    s_add_u32 m0, s80, 110592
    s_add_u32 s46, s43, 1548288
    buffer_load_dwordx4 v253, s[24:27], s46 offen lds
    s_waitcnt vmcnt(12)
    v_mfma_f32_16x16x32_bf16 v[132:135], a[0:3], v[32:35], v[132:135]
    buffer_load_dwordx4 v[76:79], v10, s[16:19], s37 offen offset:3072 sc1
    v_mfma_f32_16x16x32_bf16 v[136:139], a[4:7], v[32:35], v[136:139]
    v_mfma_f32_16x16x32_bf16 v[140:143], a[8:11], v[32:35], v[140:143]
    v_mfma_f32_16x16x32_bf16 v[144:147], a[12:15], v[32:35], v[144:147]
    s_waitcnt vmcnt(12)
    v_mfma_f32_16x16x32_bf16 v[132:135], a[16:19], v[36:39], v[132:135]
    s_add_u32 s37, s41, 12288
    buffer_load_dwordx4 v[80:83], v10, s[16:19], s37 offen offset:0 sc1
    v_mfma_f32_16x16x32_bf16 v[136:139], a[20:23], v[36:39], v[136:139]
    v_mfma_f32_16x16x32_bf16 v[140:143], a[24:27], v[36:39], v[140:143]
    v_mfma_f32_16x16x32_bf16 v[144:147], a[28:31], v[36:39], v[144:147]
    s_waitcnt vmcnt(12)
    v_mfma_f32_16x16x32_bf16 v[132:135], a[32:35], v[40:43], v[132:135]
    buffer_load_dwordx4 v[84:87], v10, s[16:19], s37 offen offset:1024 sc1
    v_mfma_f32_16x16x32_bf16 v[136:139], a[36:39], v[40:43], v[136:139]
    v_mfma_f32_16x16x32_bf16 v[140:143], a[40:43], v[40:43], v[140:143]
    v_mfma_f32_16x16x32_bf16 v[144:147], a[44:47], v[40:43], v[144:147]
    s_waitcnt vmcnt(12)
    v_mfma_f32_16x16x32_bf16 v[132:135], a[48:51], v[44:47], v[132:135]
    buffer_load_dwordx4 v[88:91], v10, s[16:19], s37 offen offset:2048 sc1
    v_mfma_f32_16x16x32_bf16 v[136:139], a[52:55], v[44:47], v[136:139]
    v_mfma_f32_16x16x32_bf16 v[140:143], a[56:59], v[44:47], v[140:143]
    v_mfma_f32_16x16x32_bf16 v[144:147], a[60:63], v[44:47], v[144:147]
    s_waitcnt vmcnt(12)
    v_mfma_f32_16x16x32_bf16 v[132:135], a[64:67], v[48:51], v[132:135]
    buffer_load_dwordx4 v[92:95], v10, s[16:19], s37 offen offset:3072 sc1
    v_mfma_f32_16x16x32_bf16 v[136:139], a[68:71], v[48:51], v[136:139]
    v_mfma_f32_16x16x32_bf16 v[140:143], a[72:75], v[48:51], v[140:143]
    v_mfma_f32_16x16x32_bf16 v[144:147], a[76:79], v[48:51], v[144:147]
    s_waitcnt vmcnt(12)
    v_mfma_f32_16x16x32_bf16 v[132:135], a[80:83], v[52:55], v[132:135]
    v_mfma_f32_16x16x32_bf16 v[136:139], a[84:87], v[52:55], v[136:139]
    v_mfma_f32_16x16x32_bf16 v[140:143], a[88:91], v[52:55], v[140:143]
    v_mfma_f32_16x16x32_bf16 v[144:147], a[92:95], v[52:55], v[144:147]
    s_waitcnt vmcnt(11)
    v_mfma_f32_16x16x32_bf16 v[132:135], a[96:99], v[56:59], v[132:135]
    v_mfma_f32_16x16x32_bf16 v[136:139], a[100:103], v[56:59], v[136:139]
    v_mfma_f32_16x16x32_bf16 v[140:143], a[104:107], v[56:59], v[140:143]
    v_mfma_f32_16x16x32_bf16 v[144:147], a[108:111], v[56:59], v[144:147]
    s_waitcnt vmcnt(10)
    v_mfma_f32_16x16x32_bf16 v[132:135], a[112:115], v[60:63], v[132:135]
    v_mfma_f32_16x16x32_bf16 v[136:139], a[116:119], v[60:63], v[136:139]
    v_mfma_f32_16x16x32_bf16 v[140:143], a[120:123], v[60:63], v[140:143]
    v_mfma_f32_16x16x32_bf16 v[144:147], a[124:127], v[60:63], v[144:147]
    s_waitcnt vmcnt(9)
    v_mfma_f32_16x16x32_bf16 v[132:135], a[128:131], v[64:67], v[132:135]
    v_mfma_f32_16x16x32_bf16 v[136:139], a[132:135], v[64:67], v[136:139]
    v_mfma_f32_16x16x32_bf16 v[140:143], a[136:139], v[64:67], v[140:143]
    v_mfma_f32_16x16x32_bf16 v[144:147], a[140:143], v[64:67], v[144:147]
    s_waitcnt vmcnt(8)
    v_mfma_f32_16x16x32_bf16 v[132:135], a[144:147], v[68:71], v[132:135]
    v_mfma_f32_16x16x32_bf16 v[136:139], a[148:151], v[68:71], v[136:139]
    v_mfma_f32_16x16x32_bf16 v[140:143], a[152:155], v[68:71], v[140:143]
    v_mfma_f32_16x16x32_bf16 v[144:147], a[156:159], v[68:71], v[144:147]
    s_waitcnt vmcnt(7)
    v_mfma_f32_16x16x32_bf16 v[132:135], a[160:163], v[72:75], v[132:135]
    v_mfma_f32_16x16x32_bf16 v[136:139], a[164:167], v[72:75], v[136:139]
    v_mfma_f32_16x16x32_bf16 v[140:143], a[168:171], v[72:75], v[140:143]
    v_mfma_f32_16x16x32_bf16 v[144:147], a[172:175], v[72:75], v[144:147]
    s_waitcnt vmcnt(4)
    v_mfma_f32_16x16x32_bf16 v[132:135], a[176:179], v[76:79], v[132:135]
    v_mfma_f32_16x16x32_bf16 v[136:139], a[180:183], v[76:79], v[136:139]
    v_mfma_f32_16x16x32_bf16 v[140:143], a[184:187], v[76:79], v[140:143]
    v_mfma_f32_16x16x32_bf16 v[144:147], a[188:191], v[76:79], v[144:147]
    s_waitcnt vmcnt(3)
    v_mfma_f32_16x16x32_bf16 v[132:135], a[192:195], v[80:83], v[132:135]
    v_mfma_f32_16x16x32_bf16 v[136:139], a[196:199], v[80:83], v[136:139]
    v_mfma_f32_16x16x32_bf16 v[140:143], a[200:203], v[80:83], v[140:143]
    v_mfma_f32_16x16x32_bf16 v[144:147], a[204:207], v[80:83], v[144:147]
    s_waitcnt vmcnt(2)
    v_mfma_f32_16x16x32_bf16 v[132:135], a[208:211], v[84:87], v[132:135]
    v_mfma_f32_16x16x32_bf16 v[136:139], a[212:215], v[84:87], v[136:139]
    v_mfma_f32_16x16x32_bf16 v[140:143], a[216:219], v[84:87], v[140:143]
    v_mfma_f32_16x16x32_bf16 v[144:147], a[220:223], v[84:87], v[144:147]
    s_waitcnt vmcnt(1)
    v_mfma_f32_16x16x32_bf16 v[132:135], a[224:227], v[88:91], v[132:135]
    v_mfma_f32_16x16x32_bf16 v[136:139], a[228:231], v[88:91], v[136:139]
    v_mfma_f32_16x16x32_bf16 v[140:143], a[232:235], v[88:91], v[140:143]
    v_mfma_f32_16x16x32_bf16 v[144:147], a[236:239], v[88:91], v[144:147]
    s_waitcnt vmcnt(0)
    v_mfma_f32_16x16x32_bf16 v[132:135], a[240:243], v[92:95], v[132:135]
    v_mfma_f32_16x16x32_bf16 v[136:139], a[244:247], v[92:95], v[136:139]
    v_mfma_f32_16x16x32_bf16 v[140:143], a[248:251], v[92:95], v[140:143]
    v_mfma_f32_16x16x32_bf16 v[144:147], a[252:255], v[92:95], v[144:147]
    s_nop 4
    v_cvt_pk_bf16_f32 v240, v132, v133
    v_cvt_pk_bf16_f32 v241, v134, v135
    v_cvt_pk_bf16_f32 v242, v136, v137
    v_cvt_pk_bf16_f32 v243, v138, v139
    v_cvt_pk_bf16_f32 v244, v140, v141
    v_cvt_pk_bf16_f32 v245, v142, v143
    v_cvt_pk_bf16_f32 v246, v144, v145
    v_cvt_pk_bf16_f32 v247, v146, v147
    s_mul_i32 s36, s40, 14
    s_lshl_b32 s37, s35, 1
    s_add_u32 s36, s36, s37
    s_lshl_b32 s36, s36, 10
    s_add_u32 s36, s36, 6291456
    s_add_u32 s37, s36, 1024
    buffer_store_dwordx4 v[240:243], v10, s[16:19], s36 offen sc1
    buffer_store_dwordx4 v[244:247], v10, s[16:19], s37 offen sc1
    v_pk_add_f32 v[16:17], v[132:133], v[134:135]
    v_pk_mul_f32 v[18:19], v[132:133], v[132:133]
    v_pk_fma_f32 v[18:19], v[134:135], v[134:135], v[18:19]
    v_pk_add_f32 v[16:17], v[16:17], v[136:137]
    v_pk_fma_f32 v[18:19], v[136:137], v[136:137], v[18:19]
    v_pk_add_f32 v[16:17], v[16:17], v[138:139]
    v_pk_fma_f32 v[18:19], v[138:139], v[138:139], v[18:19]
    v_pk_add_f32 v[16:17], v[16:17], v[140:141]
    v_pk_fma_f32 v[18:19], v[140:141], v[140:141], v[18:19]
    v_pk_add_f32 v[16:17], v[16:17], v[142:143]
    v_pk_fma_f32 v[18:19], v[142:143], v[142:143], v[18:19]
    v_pk_add_f32 v[16:17], v[16:17], v[144:145]
    v_pk_fma_f32 v[18:19], v[144:145], v[144:145], v[18:19]
    v_pk_add_f32 v[16:17], v[16:17], v[146:147]
    v_pk_fma_f32 v[18:19], v[146:147], v[146:147], v[18:19]
    v_add_f32 v14, v16, v17
    v_add_f32 v15, v18, v19
    v_mov_b32 v13, v14
    v_mov_b32 v16, v15
    s_nop 0
    v_permlane32_swap_b32 v13, v14
    v_permlane32_swap_b32 v16, v15
    v_add_f32 v14, v14, v13
    v_add_f32 v15, v15, v16
    v_mov_b32 v13, v14
    v_mov_b32 v16, v15
    s_nop 0
    v_permlane16_swap_b32 v13, v14
    v_permlane16_swap_b32 v16, v15
    v_add_f32 v14, v14, v13
    v_add_f32 v15, v15, v16
    v_lshlrev_b32 v13, 3, v1
    s_lshl_b32 s36, s40, 10
    s_lshl_b32 s37, s35, 7
    s_add_u32 s36, s36, s37
    s_add_u32 s36, s36, 8126464
    s_mov_b64 exec, 0xffff
    buffer_store_dwordx2 v[14:15], v13, s[16:19], s36 offen sc1
    s_mov_b64 exec, -1
    s_barrier
    v_add_u32 v4, s74, v224
    v_add_u32 v5, s74, v225
    v_add_u32 v6, s74, v226
    v_add_u32 v7, s74, v227
    v_mov_b32 v24, 0x3f803f80
    v_mov_b32 v25, 0x3f803f80
    v_mov_b32 v26, 0x3f803f80
    v_mov_b32 v27, 0x3f803f80
    v_lshrrev_b32 v13, 2, v1
    v_lshlrev_b32 v14, 8, v13
    v_and_b32 v12, 3, v13
    v_lshlrev_b32 v12, 1, v12
    v_bfe_u32 v13, v1, 4, 1
    v_add_u32 v12, v12, v13
    s_lshl_b32 s36, s3, 1
    v_xor_b32 v12, s36, v12
    v_lshl_add_u32 v14, v12, 5, v14
    v_and_b32 v13, 3, v1
    v_lshl_add_u32 v20, v13, 3, v14
    v_xor_b32 v21, 32, v20
    v_add_u32 v22, 65536, v20
    v_add_u32 v23, 65536, v21
    ds_read_b64_tr_b16 v[136:137], v20 offset:0
    ds_read_b64_tr_b16 v[138:139], v20 offset:4096
    ds_read_b64_tr_b16 v[140:141], v21 offset:0
    ds_read_b64_tr_b16 v[142:143], v21 offset:4096
    ds_read_b64_tr_b16 v[144:145], v20 offset:8192
    ds_read_b64_tr_b16 v[146:147], v20 offset:12288
    ds_read_b64_tr_b16 v[148:149], v21 offset:8192
    ds_read_b64_tr_b16 v[150:151], v21 offset:12288
    ds_read_b64_tr_b16 v[152:153], v20 offset:16384
    ds_read_b64_tr_b16 v[154:155], v20 offset:20480
    ds_read_b64_tr_b16 v[156:157], v21 offset:16384
    ds_read_b64_tr_b16 v[158:159], v21 offset:20480
    ds_read_b64_tr_b16 v[160:161], v20 offset:24576
    ds_read_b64_tr_b16 v[162:163], v20 offset:28672
    ds_read_b64_tr_b16 v[164:165], v21 offset:24576
    ds_read_b64_tr_b16 v[166:167], v21 offset:28672
    s_waitcnt lgkmcnt(12)
    v_mfma_f32_16x16x32_bf16 v[168:171], v[24:27], v[136:139], 0
    v_mfma_f32_16x16x32_bf16 v[172:175], v[24:27], v[140:143], 0
    ds_read_b64_tr_b16 v[136:137], v20 offset:32768
    ds_read_b64_tr_b16 v[138:139], v20 offset:36864
    ds_read_b64_tr_b16 v[140:141], v21 offset:32768
    ds_read_b64_tr_b16 v[142:143], v21 offset:36864
    s_waitcnt lgkmcnt(12)
    v_mfma_f32_16x16x32_bf16 v[168:171], v[24:27], v[144:147], v[168:171]
    v_mfma_f32_16x16x32_bf16 v[172:175], v[24:27], v[148:151], v[172:175]
    ds_read_b64_tr_b16 v[144:145], v20 offset:40960
    ds_read_b64_tr_b16 v[146:147], v20 offset:45056
    ds_read_b64_tr_b16 v[148:149], v21 offset:40960
    ds_read_b64_tr_b16 v[150:151], v21 offset:45056
    s_waitcnt lgkmcnt(12)
    v_mfma_f32_16x16x32_bf16 v[168:171], v[24:27], v[152:155], v[168:171]
    v_mfma_f32_16x16x32_bf16 v[172:175], v[24:27], v[156:159], v[172:175]
    ds_read_b64_tr_b16 v[152:153], v20 offset:49152
    ds_read_b64_tr_b16 v[154:155], v20 offset:53248
    ds_read_b64_tr_b16 v[156:157], v21 offset:49152
    ds_read_b64_tr_b16 v[158:159], v21 offset:53248
    s_waitcnt lgkmcnt(12)
    v_mfma_f32_16x16x32_bf16 v[168:171], v[24:27], v[160:163], v[168:171]
    v_mfma_f32_16x16x32_bf16 v[172:175], v[24:27], v[164:167], v[172:175]
    ds_read_b64_tr_b16 v[160:161], v20 offset:57344
    ds_read_b64_tr_b16 v[162:163], v20 offset:61440
    ds_read_b64_tr_b16 v[164:165], v21 offset:57344
    ds_read_b64_tr_b16 v[166:167], v21 offset:61440
    s_waitcnt lgkmcnt(12)
    v_mfma_f32_16x16x32_bf16 v[168:171], v[24:27], v[136:139], v[168:171]
    v_mfma_f32_16x16x32_bf16 v[172:175], v[24:27], v[140:143], v[172:175]
    ds_read_b64_tr_b16 v[136:137], v22 offset:0
    ds_read_b64_tr_b16 v[138:139], v22 offset:4096
    ds_read_b64_tr_b16 v[140:141], v23 offset:0
    ds_read_b64_tr_b16 v[142:143], v23 offset:4096
    s_waitcnt lgkmcnt(12)
    v_mfma_f32_16x16x32_bf16 v[168:171], v[24:27], v[144:147], v[168:171]
    v_mfma_f32_16x16x32_bf16 v[172:175], v[24:27], v[148:151], v[172:175]
    s_waitcnt vmcnt(0)
    s_barrier
    s_cmp_lg_u32 s3, 0
    s_cbranch_scc1 OW_15
    s_lshl_b32 s36, s32, 9
    s_lshl_b32 s37, s33, 2
    s_add_u32 s36, s36, s37
    s_add_u32 s36, s36, 8323136
    v_mov_b32 v13, 0
    v_mov_b32 v14, 1
    s_mov_b64 exec, 1
    buffer_store_dword v14, v13, s[16:19], s36 offen sc1
    s_mov_b64 exec, -1
OW_15:
    ds_read_b64_tr_b16 v[144:145], v22 offset:8192
    ds_read_b64_tr_b16 v[146:147], v22 offset:12288
    ds_read_b64_tr_b16 v[148:149], v23 offset:8192
    ds_read_b64_tr_b16 v[150:151], v23 offset:12288
    s_waitcnt lgkmcnt(12)
    v_mfma_f32_16x16x32_bf16 v[168:171], v[24:27], v[152:155], v[168:171]
    v_mfma_f32_16x16x32_bf16 v[172:175], v[24:27], v[156:159], v[172:175]
    s_mul_i32 s72, s50, 28672
    s_add_u32 s72, s72, s75
    s_add_u32 m0, s74, 0
    s_nop 0
    buffer_load_dwordx4 v252, s[76:79], s72 offen offset:0 lds
    ds_read_b64_tr_b16 v[152:153], v22 offset:16384
    ds_read_b64_tr_b16 v[154:155], v22 offset:20480
    ds_read_b64_tr_b16 v[156:157], v23 offset:16384
    ds_read_b64_tr_b16 v[158:159], v23 offset:20480
    s_waitcnt lgkmcnt(12)
    v_mfma_f32_16x16x32_bf16 v[168:171], v[24:27], v[160:163], v[168:171]
    v_mfma_f32_16x16x32_bf16 v[172:175], v[24:27], v[164:167], v[172:175]
    s_add_u32 s72, s72, 6144
    buffer_load_dwordx4 v252, s[76:79], s72 offen offset:1024 lds
    ds_read_b64_tr_b16 v[160:161], v22 offset:24576
    ds_read_b64_tr_b16 v[162:163], v22 offset:28672
    ds_read_b64_tr_b16 v[164:165], v23 offset:24576
    ds_read_b64_tr_b16 v[166:167], v23 offset:28672
    s_waitcnt lgkmcnt(12)
    v_mfma_f32_16x16x32_bf16 v[168:171], v[24:27], v[136:139], v[168:171]
    v_mfma_f32_16x16x32_bf16 v[172:175], v[24:27], v[140:143], v[172:175]
    s_add_u32 s72, s72, 6144
    buffer_load_dwordx4 v252, s[76:79], s72 offen offset:2048 lds
    ds_read_b64_tr_b16 v[136:137], v22 offset:32768
    ds_read_b64_tr_b16 v[138:139], v22 offset:36864
    ds_read_b64_tr_b16 v[140:141], v23 offset:32768
    ds_read_b64_tr_b16 v[142:143], v23 offset:36864
    s_waitcnt lgkmcnt(12)
    v_mfma_f32_16x16x32_bf16 v[168:171], v[24:27], v[144:147], v[168:171]
    v_mfma_f32_16x16x32_bf16 v[172:175], v[24:27], v[148:151], v[172:175]
    s_add_u32 s72, s72, 6144
    buffer_load_dwordx4 v252, s[76:79], s72 offen offset:3072 lds
    ds_read_b64_tr_b16 v[144:145], v22 offset:40960
    ds_read_b64_tr_b16 v[146:147], v22 offset:45056
    ds_read_b64_tr_b16 v[148:149], v23 offset:40960
    ds_read_b64_tr_b16 v[150:151], v23 offset:45056
    s_waitcnt lgkmcnt(12)
    v_mfma_f32_16x16x32_bf16 v[168:171], v[24:27], v[152:155], v[168:171]
    v_mfma_f32_16x16x32_bf16 v[172:175], v[24:27], v[156:159], v[172:175]
    s_mul_i32 s72, s51, 28672
    s_add_u32 s72, s72, s75
    s_add_u32 m0, s74, 4096
    s_nop 0
    buffer_load_dwordx4 v252, s[76:79], s72 offen offset:0 lds
    s_waitcnt lgkmcnt(8)
    v_mfma_f32_16x16x32_bf16 v[168:171], v[24:27], v[160:163], v[168:171]
    v_mfma_f32_16x16x32_bf16 v[172:175], v[24:27], v[164:167], v[172:175]
    s_add_u32 s72, s72, 6144
    buffer_load_dwordx4 v252, s[76:79], s72 offen offset:1024 lds
    s_waitcnt lgkmcnt(4)
    v_mfma_f32_16x16x32_bf16 v[168:171], v[24:27], v[136:139], v[168:171]
    v_mfma_f32_16x16x32_bf16 v[172:175], v[24:27], v[140:143], v[172:175]
    s_add_u32 s72, s72, 6144
    buffer_load_dwordx4 v252, s[76:79], s72 offen offset:2048 lds
    s_waitcnt lgkmcnt(0)
    v_mfma_f32_16x16x32_bf16 v[168:171], v[24:27], v[144:147], v[168:171]
    v_mfma_f32_16x16x32_bf16 v[172:175], v[24:27], v[148:151], v[172:175]
    s_add_u32 s72, s72, 6144
    buffer_load_dwordx4 v252, s[76:79], s72 offen offset:3072 lds
    v_and_b32 v13, 15, v1
    v_lshlrev_b32 v13, 2, v13
    s_lshl_b32 s36, s3, 7
    s_add_u32 s36, s36, 122880
    v_add_u32 v12, s36, v13
    s_mov_b64 exec, 0xffff
    ds_write_b32 v12, v168
    ds_write_b32 v12, v172 offset:64
    s_mov_b64 exec, -1
    s_waitcnt lgkmcnt(0)
    s_barrier
    s_cmp_lg_u32 s3, 1
    s_cbranch_scc1 OW_16
    v_min_u32 v2, 13, v1
    v_lshlrev_b32 v2, 2, v2
    s_lshl_b32 s47, s32, 9
    s_add_u32 s47, s47, 8323136
    buffer_load_dword v0, v2, s[16:19], s47 offen sc1
OW_16:
    v_and_b32 v13, 31, v1
    v_lshlrev_b32 v13, 2, v13
    v_add_u32 v12, 122880, v13
    ds_read_b32 v152, v12 offset:0
    ds_read_b32 v153, v12 offset:128
    ds_read_b32 v154, v12 offset:256
    ds_read_b32 v155, v12 offset:384
    s_lshl_b32 s41, s32, 3
    s_lshl_b32 s37, s3, 1
    s_add_u32 s41, s41, s37
    v_and_b32 v13, 15, v1
    v_lshrrev_b32 v14, 5, v1
    v_lshl_add_u32 v12, v14, 4, v13
    v_lshlrev_b32 v12, 4, v12
    v_bfe_u32 v21, v1, 4, 1
    s_movk_i32 s36, 14336
    v_mad_u32_u24 v15, v21, s36, v12
    s_mov_b32 s36, 57344
    v_mad_u32_u24 v20, v21, s36, v12
    v_lshlrev_b32 v13, 3, v13
    v_lshl_add_u32 v13, v14, 7, v13
    v_lshl_add_u32 v21, v21, 10, v13
    v_cmp_lt_u32 s[66:67], 31, v1
    v_and_b32 v13, 15, v1
    v_lshlrev_b32 v13, 3, v13
    v_lshrrev_b32 v14, 4, v1
    v_lshl_add_u32 v12, v14, 7, v13
    s_mul_i32 s43, s41, 14336
    s_add_u32 s43, s43, 6291456
    s_lshl_b32 s42, s41, 10
    s_add_u32 s42, s42, 8126464
    s_waitcnt lgkmcnt(0)
    v_cvt_pk_bf16_f32 v136, v152, v152
    v_lshlrev_b32 v13, 16, v136
    v_sub_f32 v13, v152, v13
    v_cvt_pk_bf16_f32 v137, v13, 0
    v_cndmask_b32 v136, v136, 0, s[66:67]
    v_cndmask_b32 v137, v137, 0, s[66:67]
    v_mov_b32 v138, 0
    v_mov_b32 v139, 0
    v_cvt_pk_bf16_f32 v140, v153, v153
    v_lshlrev_b32 v13, 16, v140
    v_sub_f32 v13, v153, v13
    v_cvt_pk_bf16_f32 v141, v13, 0
    v_cndmask_b32 v140, v140, 0, s[66:67]
    v_cndmask_b32 v141, v141, 0, s[66:67]
    v_mov_b32 v142, 0
    v_mov_b32 v143, 0
    v_cvt_pk_bf16_f32 v144, v154, v154
    v_lshlrev_b32 v13, 16, v144
    v_sub_f32 v13, v154, v13
    v_cvt_pk_bf16_f32 v145, v13, 0
    v_cndmask_b32 v144, v144, 0, s[66:67]
    v_cndmask_b32 v145, v145, 0, s[66:67]
    v_mov_b32 v146, 0
    v_mov_b32 v147, 0
    v_cvt_pk_bf16_f32 v148, v155, v155
    v_lshlrev_b32 v13, 16, v148
    v_sub_f32 v13, v155, v13
    v_cvt_pk_bf16_f32 v149, v13, 0
    v_cndmask_b32 v148, v148, 0, s[66:67]
    v_cndmask_b32 v149, v149, 0, s[66:67]
    v_mov_b32 v150, 0
    v_mov_b32 v151, 0
    ds_read_b64_tr_b16 a[224:225], v232 offset:0
    ds_read_b64_tr_b16 a[226:227], v232 offset:4096
    ds_read_b64_tr_b16 a[228:229], v232 offset:2048
    ds_read_b64_tr_b16 a[230:231], v232 offset:6144
    ds_read_b64_tr_b16 a[232:233], v233 offset:0
    ds_read_b64_tr_b16 a[234:235], v233 offset:4096
    ds_read_b64_tr_b16 a[236:237], v233 offset:2048
    ds_read_b64_tr_b16 a[238:239], v233 offset:6144
    ds_read_b64_tr_b16 a[240:241], v234 offset:0
    ds_read_b64_tr_b16 a[242:243], v234 offset:4096
    ds_read_b64_tr_b16 a[244:245], v234 offset:2048
    ds_read_b64_tr_b16 a[246:247], v234 offset:6144
    ds_read_b64_tr_b16 a[248:249], v235 offset:0
    ds_read_b64_tr_b16 a[250:251], v235 offset:4096
    ds_read_b64_tr_b16 a[252:253], v235 offset:2048
    ds_read_b64_tr_b16 a[254:255], v235 offset:6144
    s_cmp_lg_u32 s3, 1
    s_cbranch_scc1 OW_17
    v_min_u32 v2, 13, v1
    v_lshlrev_b32 v2, 2, v2
    s_lshl_b32 s47, s32, 9
    s_add_u32 s47, s47, 8323136
    s_mov_b32 s38, 0
PLl_18:
    s_sleep 2
    buffer_load_dword v254, v2, s[16:19], s47 offen sc1
    s_waitcnt vmcnt(1)
    v_cmp_ne_u32 vcc, 1, v0
    s_cbranch_vccz PLk_19
    s_sleep 2
    buffer_load_dword v0, v2, s[16:19], s47 offen sc1
    s_waitcnt vmcnt(1)
    v_cmp_ne_u32 vcc, 1, v254
    s_cbranch_vccz PLk_19
    s_add_u32 s38, s38, 1
    s_cmp_lt_u32 s38, 300000
    s_cbranch_scc1 PLl_18
PLk_19:
OW_17:
    s_barrier
    s_add_u32 s37, s43, 0
    buffer_load_dwordx4 v[24:27], v15, s[16:19], s37 offen offset:0 sc1
    buffer_load_dwordx4 v[28:31], v15, s[16:19], s37 offen offset:512 sc1
    buffer_load_dwordx4 v[32:35], v15, s[16:19], s37 offen offset:1024 sc1
    buffer_load_dwordx4 v[36:39], v15, s[16:19], s37 offen offset:1536 sc1
    buffer_load_dwordx4 v[40:43], v15, s[16:19], s37 offen offset:2048 sc1
    buffer_load_dwordx4 v[44:47], v15, s[16:19], s37 offen offset:2560 sc1
    buffer_load_dword v16, v21, s[16:19], s42 offen offset:0 sc1
    buffer_load_dword v17, v21, s[16:19], s42 offen offset:256 sc1
    buffer_load_dword v18, v21, s[16:19], s42 offen offset:512 sc1
    buffer_load_dword v19, v21, s[16:19], s42 offen offset:768 sc1
    buffer_load_dwordx4 v[48:51], v15, s[16:19], s37 offen offset:3072 sc1
    buffer_load_dwordx4 v[52:55], v15, s[16:19], s37 offen offset:3584 sc1
    s_add_u32 s37, s43, 4096
    buffer_load_dwordx4 v[56:59], v15, s[16:19], s37 offen offset:0 sc1
    buffer_load_dwordx4 v[60:63], v15, s[16:19], s37 offen offset:512 sc1
    s_mul_i32 s36, s41, 56
    s_lshl_b32 s38, s33, 2
    s_add_u32 s36, s36, s38
    s_lshl_b32 s36, s36, 10
    s_add_u32 s81, s36, 8388608
    s_waitcnt vmcnt(12)
    s_waitcnt lgkmcnt(14)
    v_mfma_f32_32x32x16_bf16 v[168:183], a[224:227], v[24:27], 0
    ds_read_b64_tr_b16 a[192:193], v232 offset:8192
    buffer_load_dwordx4 v[64:67], v15, s[16:19], s37 offen offset:1024 sc1
    ds_read_b64_tr_b16 a[194:195], v232 offset:12288
    s_waitcnt lgkmcnt(14)
    v_mfma_f32_32x32x16_bf16 v[168:183], a[228:231], v[28:31], v[168:183]
    ds_read_b64_tr_b16 a[196:197], v232 offset:10240
    ds_read_b64_tr_b16 a[198:199], v232 offset:14336
    s_waitcnt lgkmcnt(14)
    buffer_load_dwordx4 v[68:71], v15, s[16:19], s37 offen offset:1536 sc1
    v_mfma_f32_32x32x16_bf16 v[184:199], a[232:235], v[24:27], 0
    ds_read_b64_tr_b16 a[200:201], v233 offset:8192
    ds_read_b64_tr_b16 a[202:203], v233 offset:12288
    s_waitcnt lgkmcnt(14)
    v_mfma_f32_32x32x16_bf16 v[184:199], a[236:239], v[28:31], v[184:199]
    ds_read_b64_tr_b16 a[204:205], v233 offset:10240
    buffer_load_dwordx4 v[72:75], v15, s[16:19], s37 offen offset:2048 sc1
    ds_read_b64_tr_b16 a[206:207], v233 offset:14336
    s_waitcnt lgkmcnt(14)
    v_mfma_f32_32x32x16_bf16 v[200:215], a[240:243], v[24:27], 0
    ds_read_b64_tr_b16 a[208:209], v234 offset:8192
    ds_read_b64_tr_b16 a[210:211], v234 offset:12288
    s_waitcnt lgkmcnt(14)
    buffer_load_dwordx4 v[76:79], v15, s[16:19], s37 offen offset:2560 sc1
    v_mfma_f32_32x32x16_bf16 v[200:215], a[244:247], v[28:31], v[200:215]
    ds_read_b64_tr_b16 a[212:213], v234 offset:10240
    ds_read_b64_tr_b16 a[214:215], v234 offset:14336
    s_waitcnt lgkmcnt(14)
    v_mfma_f32_32x32x16_bf16 v[216:231], a[248:251], v[24:27], 0
    ds_read_b64_tr_b16 a[216:217], v235 offset:8192
    ds_read_b64_tr_b16 a[218:219], v235 offset:12288
    s_waitcnt lgkmcnt(14)
    v_mfma_f32_32x32x16_bf16 v[216:231], a[252:255], v[28:31], v[216:231]
    ds_read_b64_tr_b16 a[220:221], v235 offset:10240
    ds_read_b64_tr_b16 a[222:223], v235 offset:14336
    s_waitcnt vmcnt(14)
    s_waitcnt lgkmcnt(14)
    v_mfma_f32_32x32x16_bf16 v[168:183], a[192:195], v[32:35], v[168:183]
    ds_read_b64_tr_b16 a[224:225], v232 offset:16384
    buffer_load_dwordx4 v[80:83], v15, s[16:19], s37 offen offset:3072 sc1
    ds_read_b64_tr_b16 a[226:227], v232 offset:20480
    s_waitcnt lgkmcnt(14)
    v_mfma_f32_32x32x16_bf16 v[168:183], a[196:199], v[36:39], v[168:183]
    ds_read_b64_tr_b16 a[228:229], v232 offset:18432
    ds_read_b64_tr_b16 a[230:231], v232 offset:22528
    s_waitcnt lgkmcnt(14)
    v_mfma_f32_32x32x16_bf16 v[184:199], a[200:203], v[32:35], v[184:199]
    buffer_load_dwordx4 v[84:87], v15, s[16:19], s37 offen offset:3584 sc1
    ds_read_b64_tr_b16 a[232:233], v233 offset:16384
    ds_read_b64_tr_b16 a[234:235], v233 offset:20480
    s_waitcnt lgkmcnt(14)
    v_mfma_f32_32x32x16_bf16 v[184:199], a[204:207], v[36:39], v[184:199]
    ds_read_b64_tr_b16 a[236:237], v233 offset:18432
    ds_read_b64_tr_b16 a[238:239], v233 offset:22528
    s_waitcnt lgkmcnt(14)
    s_add_u32 s37, s43, 8192
    buffer_load_dwordx4 v[88:91], v15, s[16:19], s37 offen offset:0 sc1
    s_waitcnt vmcnt(25)
    v_mfma_f32_32x32x16_bf16 v[200:215], a[208:211], v[32:35], v[200:215]
    ds_read_b64_tr_b16 a[240:241], v234 offset:16384
    ds_read_b64_tr_b16 a[0:1], v4 offset:0
    ds_read_b64_tr_b16 a[242:243], v234 offset:20480
    s_waitcnt lgkmcnt(15)
    ds_read_b64_tr_b16 a[2:3], v4 offset:2048
    buffer_load_dwordx4 v[92:95], v15, s[16:19], s37 offen offset:512 sc1
    v_mfma_f32_32x32x16_bf16 v[200:215], a[212:215], v[36:39], v[200:215]
    ds_read_b64_tr_b16 a[244:245], v234 offset:18432
    ds_read_b64_tr_b16 a[4:5], v5 offset:0
    ds_read_b64_tr_b16 a[246:247], v234 offset:22528
    s_waitcnt lgkmcnt(15)
    ds_read_b64_tr_b16 a[6:7], v5 offset:2048
    v_mfma_f32_32x32x16_bf16 v[216:231], a[216:219], v[32:35], v[216:231]
    ds_read_b64_tr_b16 a[248:249], v235 offset:16384
    ds_read_b64_tr_b16 a[8:9], v6 offset:0
    ds_read_b64_tr_b16 a[250:251], v235 offset:20480
    s_waitcnt lgkmcnt(15)
    ds_read_b64_tr_b16 a[10:11], v6 offset:2048
    v_mfma_f32_32x32x16_bf16 v[216:231], a[220:223], v[36:39], v[216:231]
    ds_read_b64_tr_b16 a[252:253], v235 offset:18432
    ds_read_b64_tr_b16 a[12:13], v7 offset:0
    ds_read_b64_tr_b16 a[254:255], v235 offset:22528
    ds_read_b64_tr_b16 a[14:15], v7 offset:2048
    s_waitcnt vmcnt(16)
    s_waitcnt lgkmcnt(15)
    v_mfma_f32_32x32x16_bf16 v[168:183], a[224:227], v[40:43], v[168:183]
    ds_read_b64_tr_b16 a[192:193], v232 offset:24576
    buffer_load_dwordx4 v[96:99], v15, s[16:19], s37 offen offset:1024 sc1
    ds_read_b64_tr_b16 a[194:195], v232 offset:28672
    s_waitcnt lgkmcnt(15)
    v_mfma_f32_32x32x16_bf16 v[168:183], a[228:231], v[44:47], v[168:183]
    ds_read_b64_tr_b16 a[196:197], v232 offset:26624
    ds_read_b64_tr_b16 a[198:199], v232 offset:30720
    s_waitcnt lgkmcnt(15)
    v_mfma_f32_32x32x16_bf16 v[184:199], a[232:235], v[40:43], v[184:199]
    buffer_load_dwordx4 v[100:103], v15, s[16:19], s37 offen offset:1536 sc1
    ds_read_b64_tr_b16 a[200:201], v233 offset:24576
    ds_read_b64_tr_b16 a[202:203], v233 offset:28672
    s_waitcnt lgkmcnt(15)
    v_mfma_f32_32x32x16_bf16 v[184:199], a[236:239], v[44:47], v[184:199]
    ds_read_b64_tr_b16 a[204:205], v233 offset:26624
    ds_read_b64_tr_b16 a[206:207], v233 offset:30720
    s_waitcnt lgkmcnt(15)
    buffer_load_dwordx4 v[104:107], v15, s[16:19], s37 offen offset:2048 sc1
    s_waitcnt vmcnt(25)
    v_mfma_f32_32x32x16_bf16 v[200:215], a[240:243], v[40:43], v[200:215]
    ds_read_b64_tr_b16 a[208:209], v234 offset:24576
    ds_read_b64_tr_b16 a[16:17], v4 offset:4096
    ds_read_b64_tr_b16 a[210:211], v234 offset:28672
    s_waitcnt lgkmcnt(15)
    ds_read_b64_tr_b16 a[18:19], v4 offset:6144
    buffer_load_dwordx4 v[108:111], v15, s[16:19], s37 offen offset:2560 sc1
    v_mfma_f32_32x32x16_bf16 v[200:215], a[244:247], v[44:47], v[200:215]
    ds_read_b64_tr_b16 a[212:213], v234 offset:26624
    ds_read_b64_tr_b16 a[20:21], v5 offset:4096
    ds_read_b64_tr_b16 a[214:215], v234 offset:30720
    s_waitcnt lgkmcnt(15)
    ds_read_b64_tr_b16 a[22:23], v5 offset:6144
    v_mfma_f32_32x32x16_bf16 v[216:231], a[248:251], v[40:43], v[216:231]
    ds_read_b64_tr_b16 a[216:217], v235 offset:24576
    ds_read_b64_tr_b16 a[24:25], v6 offset:4096
    ds_read_b64_tr_b16 a[218:219], v235 offset:28672
    s_waitcnt lgkmcnt(15)
    ds_read_b64_tr_b16 a[26:27], v6 offset:6144
    v_mfma_f32_32x32x16_bf16 v[216:231], a[252:255], v[44:47], v[216:231]
    ds_read_b64_tr_b16 a[220:221], v235 offset:26624
    ds_read_b64_tr_b16 a[28:29], v7 offset:4096
    ds_read_b64_tr_b16 a[222:223], v235 offset:30720
    ds_read_b64_tr_b16 a[30:31], v7 offset:6144
    s_waitcnt vmcnt(14)
    s_waitcnt lgkmcnt(15)
    v_mfma_f32_32x32x16_bf16 v[168:183], a[192:195], v[48:51], v[168:183]
    ds_read_b64_tr_b16 a[224:225], v232 offset:32768
    buffer_load_dwordx4 v[112:115], v15, s[16:19], s37 offen offset:3072 sc1
    ds_read_b64_tr_b16 a[226:227], v232 offset:36864
    buffer_load_dwordx4 v[116:119], v15, s[16:19], s37 offen offset:3584 sc1
    s_waitcnt lgkmcnt(15)
    s_add_u32 s37, s43, 12288
    buffer_load_dwordx4 v[120:123], v15, s[16:19], s37 offen offset:0 sc1
    v_mfma_f32_32x32x16_bf16 v[168:183], a[196:199], v[52:55], v[168:183]
    buffer_load_dwordx4 v[124:127], v15, s[16:19], s37 offen offset:512 sc1
    ds_read_b64_tr_b16 a[228:229], v232 offset:34816
    s_waitcnt vmcnt(20)
    ds_read_b64_tr_b16 a[230:231], v232 offset:38912
    v_cndmask_b32 v19, v19, 0, s[66:67]
    s_waitcnt lgkmcnt(15)
    v_add_f32 v16, v16, v17
    v_mfma_f32_32x32x16_bf16 v[184:199], a[200:203], v[48:51], v[184:199]
    v_add_f32 v18, v18, v19
    ds_read_b64_tr_b16 a[232:233], v233 offset:32768
    v_add_f32 v16, v16, v18
    ds_read_b64_tr_b16 a[234:235], v233 offset:36864
    v_mov_b32 v13, v16
    s_waitcnt lgkmcnt(15)
    s_nop 0
    v_permlane32_swap_b32 v13, v16
    v_mfma_f32_32x32x16_bf16 v[184:199], a[204:207], v[52:55], v[184:199]
    v_add_f32 v16, v16, v13
    ds_read_b64_tr_b16 a[236:237], v233 offset:34816
    v_mul_f32 v13, 0xbb124925, v16
    ds_read_b64_tr_b16 a[238:239], v233 offset:38912
    v_cvt_pk_bf16_f32 v17, v13, 0
    s_waitcnt lgkmcnt(15)
    v_lshlrev_b32 v14, 16, v17
    v_mfma_f32_32x32x16_bf16 v[200:215], a[208:211], v[48:51], v[200:215]
    v_sub_f32 v14, v13, v14
    ds_read_b64_tr_b16 a[240:241], v234 offset:32768
    v_cvt_pk_bf16_f32 v16, v13, v14
    ds_read_b64_tr_b16 a[242:243], v234 offset:36864
    v_mov_b32 v18, 0
    s_waitcnt lgkmcnt(15)
    v_mov_b32 v19, 0
    v_mfma_f32_32x32x16_bf16 v[200:215], a[212:215], v[52:55], v[200:215]
    ds_read_b64_tr_b16 a[244:245], v234 offset:34816
    ds_read_b64_tr_b16 a[246:247], v234 offset:38912
    s_waitcnt lgkmcnt(15)
    v_mfma_f32_32x32x16_bf16 v[216:231], a[216:219], v[48:51], v[216:231]
    ds_read_b64_tr_b16 a[248:249], v235 offset:32768
    ds_read_b64_tr_b16 a[250:251], v235 offset:36864
    s_waitcnt lgkmcnt(15)
    v_mfma_f32_32x32x16_bf16 v[216:231], a[220:223], v[52:55], v[216:231]
    ds_read_b64_tr_b16 a[252:253], v235 offset:34816
    ds_read_b64_tr_b16 a[254:255], v235 offset:38912
    s_waitcnt vmcnt(16)
    s_waitcnt lgkmcnt(14)
    v_mfma_f32_32x32x16_bf16 v[168:183], a[224:227], v[56:59], v[168:183]
    ds_read_b64_tr_b16 a[192:193], v232 offset:40960
    buffer_load_dwordx4 v[128:131], v15, s[16:19], s37 offen offset:1024 sc1
    ds_read_b64_tr_b16 a[194:195], v232 offset:45056
    s_waitcnt lgkmcnt(14)
    v_mfma_f32_32x32x16_bf16 v[168:183], a[228:231], v[60:63], v[168:183]
    ds_read_b64_tr_b16 a[196:197], v232 offset:43008
    ds_read_b64_tr_b16 a[198:199], v232 offset:47104
    s_waitcnt lgkmcnt(14)
    v_mfma_f32_32x32x16_bf16 v[184:199], a[232:235], v[56:59], v[184:199]
    ds_read_b64_tr_b16 a[200:201], v233 offset:40960
    ds_read_b64_tr_b16 a[202:203], v233 offset:45056
    s_waitcnt lgkmcnt(14)
    buffer_load_dwordx4 v[132:135], v15, s[16:19], s37 offen offset:1536 sc1
    v_mfma_f32_32x32x16_bf16 v[184:199], a[236:239], v[60:63], v[184:199]
    ds_read_b64_tr_b16 a[204:205], v233 offset:43008
    ds_read_b64_tr_b16 a[206:207], v233 offset:47104
    s_waitcnt lgkmcnt(14)
    v_mfma_f32_32x32x16_bf16 v[200:215], a[240:243], v[56:59], v[200:215]
    ds_read_b64_tr_b16 a[208:209], v234 offset:40960
    ds_read_b64_tr_b16 a[210:211], v234 offset:45056
    s_waitcnt lgkmcnt(14)
    v_mfma_f32_32x32x16_bf16 v[200:215], a[244:247], v[60:63], v[200:215]
    ds_read_b64_tr_b16 a[212:213], v234 offset:43008
    ds_read_b64_tr_b16 a[214:215], v234 offset:47104
    s_waitcnt lgkmcnt(14)
    v_mfma_f32_32x32x16_bf16 v[216:231], a[248:251], v[56:59], v[216:231]
    ds_read_b64_tr_b16 a[216:217], v235 offset:40960
    ds_read_b64_tr_b16 a[218:219], v235 offset:45056
    s_waitcnt lgkmcnt(14)
    v_mfma_f32_32x32x16_bf16 v[216:231], a[252:255], v[60:63], v[216:231]
    ds_read_b64_tr_b16 a[220:221], v235 offset:43008
    ds_read_b64_tr_b16 a[222:223], v235 offset:47104
    s_waitcnt vmcnt(16)
    s_waitcnt lgkmcnt(14)
    v_mfma_f32_32x32x16_bf16 v[168:183], a[192:195], v[64:67], v[168:183]
    ds_read_b64_tr_b16 a[224:225], v232 offset:49152
    s_mul_i32 s72, s52, 28672
    s_add_u32 s72, s72, s75
    s_add_u32 m0, s74, 8192
    s_nop 0
    buffer_load_dwordx4 v252, s[76:79], s72 offen offset:0 lds
    ds_read_b64_tr_b16 a[226:227], v232 offset:53248
    s_waitcnt lgkmcnt(14)
    v_mfma_f32_32x32x16_bf16 v[168:183], a[196:199], v[68:71], v[168:183]
    ds_read_b64_tr_b16 a[228:229], v232 offset:51200
    ds_read_b64_tr_b16 a[230:231], v232 offset:55296
    s_waitcnt lgkmcnt(14)
    s_add_u32 s72, s72, 6144
    buffer_load_dwordx4 v252, s[76:79], s72 offen offset:1024 lds
    v_mfma_f32_32x32x16_bf16 v[184:199], a[200:203], v[64:67], v[184:199]
    ds_read_b64_tr_b16 a[232:233], v233 offset:49152
    ds_read_b64_tr_b16 a[234:235], v233 offset:53248
    s_waitcnt lgkmcnt(14)
    v_mfma_f32_32x32x16_bf16 v[184:199], a[204:207], v[68:71], v[184:199]
    ds_read_b64_tr_b16 a[236:237], v233 offset:51200
    s_add_u32 s72, s72, 6144
    buffer_load_dwordx4 v252, s[76:79], s72 offen offset:2048 lds
    ds_read_b64_tr_b16 a[238:239], v233 offset:55296
    s_waitcnt lgkmcnt(14)
    v_mfma_f32_32x32x16_bf16 v[200:215], a[208:211], v[64:67], v[200:215]
    ds_read_b64_tr_b16 a[240:241], v234 offset:49152
    ds_read_b64_tr_b16 a[242:243], v234 offset:53248
    s_waitcnt lgkmcnt(14)
    s_add_u32 s72, s72, 6144
    buffer_load_dwordx4 v252, s[76:79], s72 offen offset:3072 lds
    v_mfma_f32_32x32x16_bf16 v[200:215], a[212:215], v[68:71], v[200:215]
    ds_read_b64_tr_b16 a[244:245], v234 offset:51200
    ds_read_b64_tr_b16 a[246:247], v234 offset:55296
    s_waitcnt lgkmcnt(14)
    v_mfma_f32_32x32x16_bf16 v[216:231], a[216:219], v[64:67], v[216:231]
    ds_read_b64_tr_b16 a[248:249], v235 offset:49152
    ds_read_b64_tr_b16 a[250:251], v235 offset:53248
    s_waitcnt lgkmcnt(14)
    v_mfma_f32_32x32x16_bf16 v[216:231], a[220:223], v[68:71], v[216:231]
    ds_read_b64_tr_b16 a[252:253], v235 offset:51200
    ds_read_b64_tr_b16 a[254:255], v235 offset:55296
    s_waitcnt vmcnt(18)
    s_waitcnt lgkmcnt(14)
    v_mfma_f32_32x32x16_bf16 v[168:183], a[224:227], v[72:75], v[168:183]
    ds_read_b64_tr_b16 a[192:193], v232 offset:57344
    s_mul_i32 s72, s53, 28672
    s_add_u32 s72, s72, s75
    s_add_u32 m0, s74, 0
    s_nop 0
    buffer_load_dwordx4 v252, s[76:79], s72 offen offset:0 lds
    ds_read_b64_tr_b16 a[194:195], v232 offset:61440
    s_waitcnt lgkmcnt(14)
    v_mfma_f32_32x32x16_bf16 v[168:183], a[228:231], v[76:79], v[168:183]
    ds_read_b64_tr_b16 a[196:197], v232 offset:59392
    ds_read_b64_tr_b16 a[198:199], v232 offset:63488
    s_add_u32 s72, s72, 6144
    buffer_load_dwordx4 v252, s[76:79], s72 offen offset:1024 lds
    v_mfma_f32_32x32x16_bf16 v[168:183], v[136:139], v[16:19], v[168:183]
    s_waitcnt lgkmcnt(14)
    v_mfma_f32_32x32x16_bf16 v[184:199], a[232:235], v[72:75], v[184:199]
    ds_read_b64_tr_b16 a[200:201], v233 offset:57344
    ds_read_b64_tr_b16 a[202:203], v233 offset:61440
    s_add_u32 s72, s72, 6144
    buffer_load_dwordx4 v252, s[76:79], s72 offen offset:2048 lds
    s_waitcnt lgkmcnt(14)
    v_mfma_f32_32x32x16_bf16 v[184:199], a[236:239], v[76:79], v[184:199]
    ds_read_b64_tr_b16 a[204:205], v233 offset:59392
    ds_read_b64_tr_b16 a[206:207], v233 offset:63488
    v_mfma_f32_32x32x16_bf16 v[184:199], v[140:143], v[16:19], v[184:199]
    s_add_u32 s72, s72, 6144
    buffer_load_dwordx4 v252, s[76:79], s72 offen offset:3072 lds
    s_waitcnt lgkmcnt(14)
    v_mfma_f32_32x32x16_bf16 v[200:215], a[240:243], v[72:75], v[200:215]
    ds_read_b64_tr_b16 a[208:209], v234 offset:57344
    ds_read_b64_tr_b16 a[210:211], v234 offset:61440
    s_waitcnt lgkmcnt(14)
    s_lshl_b32 s36, s40, 10
    s_add_u32 s36, s36, 8126464
    buffer_load_dwordx2 v[248:249], v12, s[16:19], s36 offen sc1
    buffer_load_dwordx2 v[250:251], v12, s[16:19], s36 offen offset:512 sc1
    v_mfma_f32_32x32x16_bf16 v[200:215], a[244:247], v[76:79], v[200:215]
    ds_read_b64_tr_b16 a[212:213], v234 offset:59392
    ds_read_b64_tr_b16 a[214:215], v234 offset:63488
    v_mfma_f32_32x32x16_bf16 v[200:215], v[144:147], v[16:19], v[200:215]
    s_waitcnt lgkmcnt(14)
    v_mfma_f32_32x32x16_bf16 v[216:231], a[248:251], v[72:75], v[216:231]
    ds_read_b64_tr_b16 a[216:217], v235 offset:57344
    ds_read_b64_tr_b16 a[218:219], v235 offset:61440
    s_waitcnt lgkmcnt(14)
    v_mfma_f32_32x32x16_bf16 v[216:231], a[252:255], v[76:79], v[216:231]
    ds_read_b64_tr_b16 a[220:221], v235 offset:59392
    ds_read_b64_tr_b16 a[222:223], v235 offset:63488
    v_mfma_f32_32x32x16_bf16 v[216:231], v[148:151], v[16:19], v[216:231]
    s_waitcnt vmcnt(22)
    v_add_u32 v232, 65536, v232
    s_waitcnt lgkmcnt(14)
    v_mfma_f32_32x32x16_bf16 v[168:183], a[192:195], v[80:83], v[168:183]
    s_mul_i32 s72, s54, 28672
    s_add_u32 s72, s72, s75
    s_add_u32 m0, s74, 4096
    s_nop 0
    buffer_load_dwordx4 v252, s[76:79], s72 offen offset:0 lds
    ds_read_b64_tr_b16 a[224:225], v232 offset:0
    ds_read_b64_tr_b16 a[226:227], v232 offset:4096
    s_waitcnt lgkmcnt(14)
    v_mfma_f32_32x32x16_bf16 v[168:183], a[196:199], v[84:87], v[168:183]
    ds_read_b64_tr_b16 a[228:229], v232 offset:2048
    ds_read_b64_tr_b16 a[230:231], v232 offset:6144
    s_add_u32 s72, s72, 6144
    buffer_load_dwordx4 v252, s[76:79], s72 offen offset:1024 lds
    v_add_u32 v233, 65536, v233
    s_waitcnt lgkmcnt(14)
    v_mfma_f32_32x32x16_bf16 v[184:199], a[200:203], v[80:83], v[184:199]
    ds_read_b64_tr_b16 a[232:233], v233 offset:0
    ds_read_b64_tr_b16 a[234:235], v233 offset:4096
    s_waitcnt lgkmcnt(14)
    s_add_u32 s72, s72, 6144
    buffer_load_dwordx4 v252, s[76:79], s72 offen offset:2048 lds
    v_mfma_f32_32x32x16_bf16 v[184:199], a[204:207], v[84:87], v[184:199]
    ds_read_b64_tr_b16 a[236:237], v233 offset:2048
    ds_read_b64_tr_b16 a[238:239], v233 offset:6144
    v_add_u32 v234, 65536, v234
    s_waitcnt lgkmcnt(14)
    v_mfma_f32_32x32x16_bf16 v[200:215], a[208:211], v[80:83], v[200:215]
    s_add_u32 s72, s72, 6144
    buffer_load_dwordx4 v252, s[76:79], s72 offen offset:3072 lds
    ds_read_b64_tr_b16 a[240:241], v234 offset:0
    ds_read_b64_tr_b16 a[242:243], v234 offset:4096
    s_waitcnt lgkmcnt(14)
    v_mfma_f32_32x32x16_bf16 v[200:215], a[212:215], v[84:87], v[200:215]
    ds_read_b64_tr_b16 a[244:245], v234 offset:2048
    ds_read_b64_tr_b16 a[246:247], v234 offset:6144
    v_add_u32 v235, 65536, v235
    s_waitcnt lgkmcnt(14)
    v_mfma_f32_32x32x16_bf16 v[216:231], a[216:219], v[80:83], v[216:231]
    ds_read_b64_tr_b16 a[248:249], v235 offset:0
    ds_read_b64_tr_b16 a[250:251], v235 offset:4096
    s_waitcnt lgkmcnt(14)
    v_mfma_f32_32x32x16_bf16 v[216:231], a[220:223], v[84:87], v[216:231]
    ds_read_b64_tr_b16 a[252:253], v235 offset:2048
    ds_read_b64_tr_b16 a[254:255], v235 offset:6144
    s_waitcnt vmcnt(24)
    s_waitcnt lgkmcnt(14)
    v_mfma_f32_32x32x16_bf16 v[168:183], a[224:227], v[88:91], v[168:183]
    ds_read_b64_tr_b16 a[192:193], v232 offset:8192
    ds_read_b64_tr_b16 a[194:195], v232 offset:12288
    s_waitcnt lgkmcnt(14)
    v_mfma_f32_32x32x16_bf16 v[168:183], a[228:231], v[92:95], v[168:183]
    ds_read_b64_tr_b16 a[196:197], v232 offset:10240
    ds_read_b64_tr_b16 a[198:199], v232 offset:14336
    s_waitcnt lgkmcnt(14)
    v_mfma_f32_32x32x16_bf16 v[184:199], a[232:235], v[88:91], v[184:199]
    ds_read_b64_tr_b16 a[200:201], v233 offset:8192
    ds_read_b64_tr_b16 a[202:203], v233 offset:12288
    s_waitcnt lgkmcnt(14)
    v_mfma_f32_32x32x16_bf16 v[184:199], a[236:239], v[92:95], v[184:199]
    ds_read_b64_tr_b16 a[204:205], v233 offset:10240
    ds_read_b64_tr_b16 a[206:207], v233 offset:14336
    s_waitcnt lgkmcnt(14)
    s_waitcnt vmcnt(10)
    v_mfma_f32_32x32x16_bf16 v[200:215], a[240:243], v[88:91], v[200:215]
    ds_read_b64_tr_b16 a[208:209], v234 offset:8192
    ds_read_b64_tr_b16 a[32:33], v4 offset:8192
    ds_read_b64_tr_b16 a[210:211], v234 offset:12288
    s_waitcnt lgkmcnt(15)
    ds_read_b64_tr_b16 a[34:35], v4 offset:10240
    v_mfma_f32_32x32x16_bf16 v[200:215], a[244:247], v[92:95], v[200:215]
    ds_read_b64_tr_b16 a[212:213], v234 offset:10240
    ds_read_b64_tr_b16 a[36:37], v5 offset:8192
    ds_read_b64_tr_b16 a[214:215], v234 offset:14336
    s_waitcnt lgkmcnt(15)
    ds_read_b64_tr_b16 a[38:39], v5 offset:10240
    v_mfma_f32_32x32x16_bf16 v[216:231], a[248:251], v[88:91], v[216:231]
    ds_read_b64_tr_b16 a[216:217], v235 offset:8192
    ds_read_b64_tr_b16 a[40:41], v6 offset:8192
    ds_read_b64_tr_b16 a[218:219], v235 offset:12288
    s_waitcnt lgkmcnt(15)
    ds_read_b64_tr_b16 a[42:43], v6 offset:10240
    v_mfma_f32_32x32x16_bf16 v[216:231], a[252:255], v[92:95], v[216:231]
    ds_read_b64_tr_b16 a[220:221], v235 offset:10240
    ds_read_b64_tr_b16 a[44:45], v7 offset:8192
    ds_read_b64_tr_b16 a[222:223], v235 offset:14336
    ds_read_b64_tr_b16 a[46:47], v7 offset:10240
    s_waitcnt vmcnt(22)
    s_waitcnt lgkmcnt(15)
    v_mfma_f32_32x32x16_bf16 v[168:183], a[192:195], v[96:99], v[168:183]
    ds_read_b64_tr_b16 a[224:225], v232 offset:16384
    s_waitcnt lgkmcnt(1)
    ds_read_b64_tr_b16 a[226:227], v232 offset:20480
    s_waitcnt lgkmcnt(15)
    v_mfma_f32_32x32x16_bf16 v[168:183], a[196:199], v[100:103], v[168:183]
    ds_read_b64_tr_b16 a[228:229], v232 offset:18432
    ds_read_b64_tr_b16 a[230:231], v232 offset:22528
    s_waitcnt lgkmcnt(15)
    s_mul_i32 s72, s55, 28672
    s_add_u32 s72, s72, s75
    s_add_u32 m0, s74, 8192
    s_nop 0
    buffer_load_dwordx4 v252, s[76:79], s72 offen offset:0 lds
    v_mfma_f32_32x32x16_bf16 v[184:199], a[200:203], v[96:99], v[184:199]
    ds_read_b64_tr_b16 a[232:233], v233 offset:16384
    ds_read_b64_tr_b16 a[234:235], v233 offset:20480
    s_waitcnt lgkmcnt(15)
    v_mfma_f32_32x32x16_bf16 v[184:199], a[204:207], v[100:103], v[184:199]
    ds_read_b64_tr_b16 a[236:237], v233 offset:18432
    s_add_u32 s72, s72, 6144
    buffer_load_dwordx4 v252, s[76:79], s72 offen offset:1024 lds
    ds_read_b64_tr_b16 a[238:239], v233 offset:22528
    s_waitcnt lgkmcnt(15)
    s_waitcnt vmcnt(8)
    v_mfma_f32_32x32x16_bf16 v[200:215], a[208:211], v[96:99], v[200:215]
    ds_read_b64_tr_b16 a[240:241], v234 offset:16384
    ds_read_b64_tr_b16 a[48:49], v4 offset:0
    s_add_u32 s72, s72, 6144
    buffer_load_dwordx4 v252, s[76:79], s72 offen offset:2048 lds
    ds_read_b64_tr_b16 a[242:243], v234 offset:20480
    s_waitcnt lgkmcnt(15)
    ds_read_b64_tr_b16 a[50:51], v4 offset:2048
    v_mfma_f32_32x32x16_bf16 v[200:215], a[212:215], v[100:103], v[200:215]
    ds_read_b64_tr_b16 a[244:245], v234 offset:18432
    ds_read_b64_tr_b16 a[52:53], v5 offset:0
    s_add_u32 s72, s72, 6144
    buffer_load_dwordx4 v252, s[76:79], s72 offen offset:3072 lds
    ds_read_b64_tr_b16 a[246:247], v234 offset:22528
    s_waitcnt lgkmcnt(15)
    ds_read_b64_tr_b16 a[54:55], v5 offset:2048
    v_mfma_f32_32x32x16_bf16 v[216:231], a[216:219], v[96:99], v[216:231]
    ds_read_b64_tr_b16 a[248:249], v235 offset:16384
    ds_read_b64_tr_b16 a[56:57], v6 offset:0
    ds_read_b64_tr_b16 a[250:251], v235 offset:20480
    s_waitcnt lgkmcnt(15)
    ds_read_b64_tr_b16 a[58:59], v6 offset:2048
    v_mfma_f32_32x32x16_bf16 v[216:231], a[220:223], v[100:103], v[216:231]
    ds_read_b64_tr_b16 a[252:253], v235 offset:18432
    ds_read_b64_tr_b16 a[60:61], v7 offset:0
    ds_read_b64_tr_b16 a[254:255], v235 offset:22528
    ds_read_b64_tr_b16 a[62:63], v7 offset:2048
    s_waitcnt vmcnt(24)
    s_waitcnt lgkmcnt(15)
    v_mfma_f32_32x32x16_bf16 v[168:183], a[224:227], v[104:107], v[168:183]
    ds_read_b64_tr_b16 a[192:193], v232 offset:24576
    s_waitcnt lgkmcnt(1)
    ds_read_b64_tr_b16 a[194:195], v232 offset:28672
    s_waitcnt lgkmcnt(15)
    v_mfma_f32_32x32x16_bf16 v[168:183], a[228:231], v[108:111], v[168:183]
    ds_read_b64_tr_b16 a[196:197], v232 offset:26624
    ds_read_b64_tr_b16 a[198:199], v232 offset:30720
    s_waitcnt lgkmcnt(15)
    s_mul_i32 s72, s56, 28672
    s_add_u32 s72, s72, s75
    s_add_u32 m0, s74, 0
    s_nop 0
    buffer_load_dwordx4 v252, s[76:79], s72 offen offset:0 lds
    v_mfma_f32_32x32x16_bf16 v[184:199], a[232:235], v[104:107], v[184:199]
    ds_read_b64_tr_b16 a[200:201], v233 offset:24576
    ds_read_b64_tr_b16 a[202:203], v233 offset:28672
    s_waitcnt lgkmcnt(15)
    v_mfma_f32_32x32x16_bf16 v[184:199], a[236:239], v[108:111], v[184:199]
    ds_read_b64_tr_b16 a[204:205], v233 offset:26624
    s_add_u32 s72, s72, 6144
    buffer_load_dwordx4 v252, s[76:79], s72 offen offset:1024 lds
    ds_read_b64_tr_b16 a[206:207], v233 offset:30720
    s_waitcnt lgkmcnt(15)
    s_waitcnt vmcnt(6)
    v_mfma_f32_32x32x16_bf16 v[200:215], a[240:243], v[104:107], v[200:215]
    ds_read_b64_tr_b16 a[208:209], v234 offset:24576
    ds_read_b64_tr_b16 a[64:65], v4 offset:4096
    s_add_u32 s72, s72, 6144
    buffer_load_dwordx4 v252, s[76:79], s72 offen offset:2048 lds
    ds_read_b64_tr_b16 a[210:211], v234 offset:28672
    s_waitcnt lgkmcnt(15)
    ds_read_b64_tr_b16 a[66:67], v4 offset:6144
    v_mfma_f32_32x32x16_bf16 v[200:215], a[244:247], v[108:111], v[200:215]
    ds_read_b64_tr_b16 a[212:213], v234 offset:26624
    ds_read_b64_tr_b16 a[68:69], v5 offset:4096
    s_add_u32 s72, s72, 6144
    buffer_load_dwordx4 v252, s[76:79], s72 offen offset:3072 lds
    ds_read_b64_tr_b16 a[214:215], v234 offset:30720
    s_waitcnt lgkmcnt(15)
    ds_read_b64_tr_b16 a[70:71], v5 offset:6144
    v_mfma_f32_32x32x16_bf16 v[216:231], a[248:251], v[104:107], v[216:231]
    ds_read_b64_tr_b16 a[216:217], v235 offset:24576
    ds_read_b64_tr_b16 a[72:73], v6 offset:4096
    ds_read_b64_tr_b16 a[218:219], v235 offset:28672
    s_waitcnt lgkmcnt(15)
    ds_read_b64_tr_b16 a[74:75], v6 offset:6144
    v_mfma_f32_32x32x16_bf16 v[216:231], a[252:255], v[108:111], v[216:231]
    ds_read_b64_tr_b16 a[220:221], v235 offset:26624
    ds_read_b64_tr_b16 a[76:77], v7 offset:4096
    ds_read_b64_tr_b16 a[222:223], v235 offset:30720
    ds_read_b64_tr_b16 a[78:79], v7 offset:6144
    s_waitcnt vmcnt(26)
    s_waitcnt lgkmcnt(15)
    v_mfma_f32_32x32x16_bf16 v[168:183], a[192:195], v[112:115], v[168:183]
    ds_read_b64_tr_b16 a[224:225], v232 offset:32768
    ds_read_b64_tr_b16 a[226:227], v232 offset:36864
    s_waitcnt lgkmcnt(15)
    v_mfma_f32_32x32x16_bf16 v[168:183], a[196:199], v[116:119], v[168:183]
    ds_read_b64_tr_b16 a[228:229], v232 offset:34816
    ds_read_b64_tr_b16 a[230:231], v232 offset:38912
    s_waitcnt lgkmcnt(15)
    v_mfma_f32_32x32x16_bf16 v[184:199], a[200:203], v[112:115], v[184:199]
    ds_read_b64_tr_b16 a[232:233], v233 offset:32768
    ds_read_b64_tr_b16 a[234:235], v233 offset:36864
    s_waitcnt lgkmcnt(15)
    v_mfma_f32_32x32x16_bf16 v[184:199], a[204:207], v[116:119], v[184:199]
    ds_read_b64_tr_b16 a[236:237], v233 offset:34816
    ds_read_b64_tr_b16 a[238:239], v233 offset:38912
    s_waitcnt lgkmcnt(15)
    v_mfma_f32_32x32x16_bf16 v[200:215], a[208:211], v[112:115], v[200:215]
    ds_read_b64_tr_b16 a[240:241], v234 offset:32768
    ds_read_b64_tr_b16 a[242:243], v234 offset:36864
    s_waitcnt lgkmcnt(15)
    v_mfma_f32_32x32x16_bf16 v[200:215], a[212:215], v[116:119], v[200:215]
    ds_read_b64_tr_b16 a[244:245], v234 offset:34816
    ds_read_b64_tr_b16 a[246:247], v234 offset:38912
    s_waitcnt lgkmcnt(15)
    v_mfma_f32_32x32x16_bf16 v[216:231], a[216:219], v[112:115], v[216:231]
    ds_read_b64_tr_b16 a[248:249], v235 offset:32768
    ds_read_b64_tr_b16 a[250:251], v235 offset:36864
    s_waitcnt lgkmcnt(15)
    v_mfma_f32_32x32x16_bf16 v[216:231], a[220:223], v[116:119], v[216:231]
    ds_read_b64_tr_b16 a[252:253], v235 offset:34816
    ds_read_b64_tr_b16 a[254:255], v235 offset:38912
    s_waitcnt vmcnt(24)
    s_waitcnt lgkmcnt(14)
    v_mfma_f32_32x32x16_bf16 v[168:183], a[224:227], v[120:123], v[168:183]
    ds_read_b64_tr_b16 a[192:193], v232 offset:40960
    s_waitcnt vmcnt(12)
    ds_read_b64_tr_b16 a[194:195], v232 offset:45056
    v_cndmask_b32 v250, v250, 0, s[64:65]
    s_waitcnt lgkmcnt(14)
    v_add_f32 v248, v248, v250
    v_mfma_f32_32x32x16_bf16 v[168:183], a[228:231], v[124:127], v[168:183]
    v_mov_b32 v13, v248
    ds_read_b64_tr_b16 a[196:197], v232 offset:43008
    s_nop 0
    v_permlane32_swap_b32 v13, v248
    ds_read_b64_tr_b16 a[198:199], v232 offset:47104
    v_add_f32 v248, v248, v13
    s_waitcnt lgkmcnt(14)
    v_mov_b32 v13, v248
    v_mfma_f32_32x32x16_bf16 v[184:199], a[232:235], v[120:123], v[184:199]
    s_nop 0
    v_permlane16_swap_b32 v13, v248
    ds_read_b64_tr_b16 a[200:201], v233 offset:40960
    v_add_f32 v248, v248, v13
    ds_read_b64_tr_b16 a[202:203], v233 offset:45056
    v_mul_f32 v248, 0x3b124925, v248
    s_waitcnt lgkmcnt(14)
    v_cndmask_b32 v251, v251, 0, s[64:65]
    v_mfma_f32_32x32x16_bf16 v[184:199], a[236:239], v[124:127], v[184:199]
    v_add_f32 v249, v249, v251
    ds_read_b64_tr_b16 a[204:205], v233 offset:43008
    v_mov_b32 v13, v249
    ds_read_b64_tr_b16 a[206:207], v233 offset:47104
    s_nop 0
    v_permlane32_swap_b32 v13, v249
    s_waitcnt lgkmcnt(14)
    v_add_f32 v249, v249, v13
    s_waitcnt vmcnt(4)
    v_mov_b32 v13, v249
    v_mfma_f32_32x32x16_bf16 v[200:215], a[240:243], v[120:123], v[200:215]
    s_nop 0
    v_permlane16_swap_b32 v13, v249
    ds_read_b64_tr_b16 a[208:209], v234 offset:40960
    v_add_f32 v249, v249, v13
    ds_read_b64_tr_b16 a[80:81], v4 offset:8192
    v_mul_f32 v13, v248, v248
    ds_read_b64_tr_b16 a[210:211], v234 offset:45056
    s_mov_b32 s36, 0x3b124925
    s_waitcnt lgkmcnt(15)
    v_fma_f32 v13, v249, s36, -v13
    ds_read_b64_tr_b16 a[82:83], v4 offset:10240
    v_max_f32 v13, 0, v13
    v_mfma_f32_32x32x16_bf16 v[200:215], a[244:247], v[124:127], v[200:215]
    v_add_f32 v13, 0x3727c5ac, v13
    ds_read_b64_tr_b16 a[212:213], v234 offset:43008
    v_rsq_f32 v249, v13
    ds_read_b64_tr_b16 a[84:85], v5 offset:8192
    ds_read_b64_tr_b16 a[214:215], v234 offset:47104
    s_waitcnt lgkmcnt(15)
    ds_read_b64_tr_b16 a[86:87], v5 offset:10240
    v_mfma_f32_32x32x16_bf16 v[216:231], a[248:251], v[120:123], v[216:231]
    ds_read_b64_tr_b16 a[216:217], v235 offset:40960
    ds_read_b64_tr_b16 a[88:89], v6 offset:8192
    ds_read_b64_tr_b16 a[218:219], v235 offset:45056
    s_waitcnt lgkmcnt(15)
    ds_read_b64_tr_b16 a[90:91], v6 offset:10240
    v_mfma_f32_32x32x16_bf16 v[216:231], a[252:255], v[124:127], v[216:231]
    ds_read_b64_tr_b16 a[220:221], v235 offset:43008
    ds_read_b64_tr_b16 a[92:93], v7 offset:8192
    ds_read_b64_tr_b16 a[222:223], v235 offset:47104
    ds_read_b64_tr_b16 a[94:95], v7 offset:10240
    s_waitcnt vmcnt(22)
    s_waitcnt lgkmcnt(15)
    v_mfma_f32_32x32x16_bf16 v[168:183], a[192:195], v[128:131], v[168:183]
    s_waitcnt lgkmcnt(15)
    v_mfma_f32_32x32x16_bf16 v[168:183], a[196:199], v[132:135], v[168:183]
    s_waitcnt lgkmcnt(15)
    v_mfma_f32_32x32x16_bf16 v[184:199], a[200:203], v[128:131], v[184:199]
    s_waitcnt lgkmcnt(15)
    v_mfma_f32_32x32x16_bf16 v[184:199], a[204:207], v[132:135], v[184:199]
    s_nop 7
    v_cvt_pk_bf16_f32 v24, v168, v169
    v_cvt_pk_bf16_f32 v25, v170, v171
    v_cvt_pk_bf16_f32 v26, v176, v177
    v_cvt_pk_bf16_f32 v27, v178, v179
    v_cvt_pk_bf16_f32 v28, v172, v173
    v_cvt_pk_bf16_f32 v29, v174, v175
    v_cvt_pk_bf16_f32 v30, v180, v181
    v_cvt_pk_bf16_f32 v31, v182, v183
    v_pk_max_i16 v24, v24, 0
    v_pk_max_i16 v25, v25, 0
    v_pk_max_i16 v26, v26, 0
    v_pk_max_i16 v27, v27, 0
    v_pk_max_i16 v28, v28, 0
    v_pk_max_i16 v29, v29, 0
    v_pk_max_i16 v30, v30, 0
    v_pk_max_i16 v31, v31, 0
    s_add_u32 s36, s81, 0
    buffer_store_dwordx4 v[24:27], v20, s[16:19], s36 offen sc1
    buffer_store_dwordx4 v[28:31], v20, s[16:19], s36 offen offset:512 sc1
    s_waitcnt lgkmcnt(13)
    v_mfma_f32_32x32x16_bf16 v[200:215], a[208:211], v[128:131], v[200:215]
    s_waitcnt lgkmcnt(9)
    v_mfma_f32_32x32x16_bf16 v[200:215], a[212:215], v[132:135], v[200:215]
    v_cvt_pk_bf16_f32 v32, v184, v185
    v_cvt_pk_bf16_f32 v33, v186, v187
    v_cvt_pk_bf16_f32 v34, v192, v193
    v_cvt_pk_bf16_f32 v35, v194, v195
    v_cvt_pk_bf16_f32 v36, v188, v189
    s_waitcnt vmcnt(2)
    v_cvt_pk_bf16_f32 v37, v190, v191
    v_cvt_pk_bf16_f32 v38, v196, v197
    ds_read_b64_tr_b16 a[96:97], v4 offset:0
    v_cvt_pk_bf16_f32 v39, v198, v199
    v_pk_max_i16 v32, v32, 0
    ds_read_b64_tr_b16 a[98:99], v4 offset:2048
    v_pk_max_i16 v33, v33, 0
    v_pk_max_i16 v34, v34, 0
    ds_read_b64_tr_b16 a[100:101], v5 offset:0
    v_pk_max_i16 v35, v35, 0
    v_pk_max_i16 v36, v36, 0
    ds_read_b64_tr_b16 a[102:103], v5 offset:2048
    v_pk_max_i16 v37, v37, 0
    v_pk_max_i16 v38, v38, 0
    ds_read_b64_tr_b16 a[104:105], v6 offset:0
    v_pk_max_i16 v39, v39, 0
    s_add_u32 s36, s81, 1024
    buffer_store_dwordx4 v[32:35], v20, s[16:19], s36 offen sc1
    buffer_store_dwordx4 v[36:39], v20, s[16:19], s36 offen offset:512 sc1
    ds_read_b64_tr_b16 a[106:107], v6 offset:2048
    s_waitcnt lgkmcnt(11)
    v_mfma_f32_32x32x16_bf16 v[216:231], a[216:219], v[128:131], v[216:231]
    ds_read_b64_tr_b16 a[108:109], v7 offset:0
    s_waitcnt lgkmcnt(8)
    v_mfma_f32_32x32x16_bf16 v[216:231], a[220:223], v[132:135], v[216:231]
    ds_read_b64_tr_b16 a[110:111], v7 offset:2048
    v_cvt_pk_bf16_f32 v24, v200, v201
    v_cvt_pk_bf16_f32 v25, v202, v203
    v_cvt_pk_bf16_f32 v26, v208, v209
    v_cvt_pk_bf16_f32 v27, v210, v211
    v_cvt_pk_bf16_f32 v28, v204, v205
    v_cvt_pk_bf16_f32 v29, v206, v207
    v_cvt_pk_bf16_f32 v30, v212, v213
    v_cvt_pk_bf16_f32 v31, v214, v215
    v_pk_max_i16 v24, v24, 0
    v_pk_max_i16 v25, v25, 0
    v_pk_max_i16 v26, v26, 0
    v_pk_max_i16 v27, v27, 0
    v_pk_max_i16 v28, v28, 0
    v_pk_max_i16 v29, v29, 0
    v_pk_max_i16 v30, v30, 0
    v_pk_max_i16 v31, v31, 0
    s_add_u32 s36, s81, 2048
    buffer_store_dwordx4 v[24:27], v20, s[16:19], s36 offen sc1
    buffer_store_dwordx4 v[28:31], v20, s[16:19], s36 offen offset:512 sc1
    s_waitcnt lgkmcnt(0)
    s_barrier
    v_cvt_pk_bf16_f32 v32, v216, v217
    v_cvt_pk_bf16_f32 v33, v218, v219
    v_cvt_pk_bf16_f32 v34, v224, v225
    v_cvt_pk_bf16_f32 v35, v226, v227
    v_cvt_pk_bf16_f32 v36, v220, v221
    v_cvt_pk_bf16_f32 v37, v222, v223
    v_cvt_pk_bf16_f32 v38, v228, v229
    v_cvt_pk_bf16_f32 v39, v230, v231
    v_pk_max_i16 v32, v32, 0
    v_pk_max_i16 v33, v33, 0
    v_pk_max_i16 v34, v34, 0
    v_pk_max_i16 v35, v35, 0
    v_pk_max_i16 v36, v36, 0
    v_pk_max_i16 v37, v37, 0
    v_pk_max_i16 v38, v38, 0
    v_pk_max_i16 v39, v39, 0
    s_add_u32 s36, s81, 3072
    buffer_store_dwordx4 v[32:35], v20, s[16:19], s36 offen sc1
    buffer_store_dwordx4 v[36:39], v20, s[16:19], s36 offen offset:512 sc1
    s_mul_i32 s36, s3, 28672
    s_sub_u32 s37, s36, s74
    s_mov_b32 s74, s36
    v_add_u32 v144, s37, v4
    v_add_u32 v145, s37, v5
    v_add_u32 v146, s37, v6
    v_add_u32 v147, s37, v7
    s_mul_i32 s72, s57, 28672
    s_add_u32 s72, s72, s75
    s_add_u32 m0, s74, 0
    s_nop 0
    buffer_load_dwordx4 v252, s[76:79], s72 offen offset:0 lds
    s_add_u32 s72, s72, 6144
    buffer_load_dwordx4 v252, s[76:79], s72 offen offset:1024 lds
    s_add_u32 s72, s72, 6144
    buffer_load_dwordx4 v252, s[76:79], s72 offen offset:2048 lds
    s_add_u32 s72, s72, 6144
    buffer_load_dwordx4 v252, s[76:79], s72 offen offset:3072 lds
    s_mul_i32 s72, s58, 28672
    s_add_u32 s72, s72, s75
    s_add_u32 m0, s74, 4096
    s_nop 0
    buffer_load_dwordx4 v252, s[76:79], s72 offen offset:0 lds
    s_add_u32 s72, s72, 6144
    buffer_load_dwordx4 v252, s[76:79], s72 offen offset:1024 lds
    s_add_u32 s72, s72, 6144
    buffer_load_dwordx4 v252, s[76:79], s72 offen offset:2048 lds
    s_add_u32 s72, s72, 6144
    buffer_load_dwordx4 v252, s[76:79], s72 offen offset:3072 lds
    s_waitcnt vmcnt(8)
    s_barrier
    s_cmp_lg_u32 s3, 0
    s_cbranch_scc1 OW_20
    s_lshl_b32 s36, s32, 9
    s_lshl_b32 s37, s33, 2
    s_add_u32 s36, s36, s37
    s_add_u32 s36, s36, 8323200
    v_mov_b32 v13, 0
    v_mov_b32 v14, 1
    s_mov_b64 exec, 1
    buffer_store_dword v14, v13, s[16:19], s36 offen sc1
    s_mov_b64 exec, -1
OW_20:
    s_cmp_eq_u32 s3, 2
    s_cbranch_scc1 WB_21
    s_mul_i32 s72, s59, 28672
    s_add_u32 s72, s72, s75
    s_add_u32 m0, s74, 8192
    s_nop 0
    buffer_load_dwordx4 v252, s[76:79], s72 offen offset:0 lds
    s_add_u32 s72, s72, 6144
    buffer_load_dwordx4 v252, s[76:79], s72 offen offset:1024 lds
    s_add_u32 s72, s72, 6144
    buffer_load_dwordx4 v252, s[76:79], s72 offen offset:2048 lds
    s_add_u32 s72, s72, 6144
    buffer_load_dwordx4 v252, s[76:79], s72 offen offset:3072 lds
    s_mul_i32 s72, s60, 28672
    s_add_u32 s72, s72, s75
    s_add_u32 m0, s74, 12288
    s_nop 0
    buffer_load_dwordx4 v252, s[76:79], s72 offen offset:0 lds
    s_add_u32 s72, s72, 6144
    buffer_load_dwordx4 v252, s[76:79], s72 offen offset:1024 lds
    s_add_u32 s72, s72, 6144
    buffer_load_dwordx4 v252, s[76:79], s72 offen offset:2048 lds
    s_add_u32 s72, s72, 6144
    buffer_load_dwordx4 v252, s[76:79], s72 offen offset:3072 lds
    s_mul_i32 s72, s61, 28672
    s_add_u32 s72, s72, s75
    s_add_u32 m0, s74, 16384
    s_nop 0
    buffer_load_dwordx4 v252, s[76:79], s72 offen offset:0 lds
    s_add_u32 s72, s72, 6144
    buffer_load_dwordx4 v252, s[76:79], s72 offen offset:1024 lds
    s_add_u32 s72, s72, 6144
    buffer_load_dwordx4 v252, s[76:79], s72 offen offset:2048 lds
    s_add_u32 s72, s72, 6144
    buffer_load_dwordx4 v252, s[76:79], s72 offen offset:3072 lds
    s_mul_i32 s72, s62, 28672
    s_add_u32 s72, s72, s75
    s_add_u32 m0, s74, 20480
    s_nop 0
    buffer_load_dwordx4 v252, s[76:79], s72 offen offset:0 lds
    s_add_u32 s72, s72, 6144
    buffer_load_dwordx4 v252, s[76:79], s72 offen offset:1024 lds
    s_add_u32 s72, s72, 6144
    buffer_load_dwordx4 v252, s[76:79], s72 offen offset:2048 lds
    s_add_u32 s72, s72, 6144
    buffer_load_dwordx4 v252, s[76:79], s72 offen offset:3072 lds
    s_mul_i32 s72, s63, 28672
    s_add_u32 s72, s72, s75
    s_add_u32 m0, s74, 24576
    s_nop 0
    buffer_load_dwordx4 v252, s[76:79], s72 offen offset:0 lds
    s_add_u32 s72, s72, 6144
    buffer_load_dwordx4 v252, s[76:79], s72 offen offset:1024 lds
    s_add_u32 s72, s72, 6144
    buffer_load_dwordx4 v252, s[76:79], s72 offen offset:2048 lds
    s_add_u32 s72, s72, 6144
    buffer_load_dwordx4 v252, s[76:79], s72 offen offset:3072 lds
    s_cmp_lg_u32 s3, 0
    s_cbranch_scc1 WBo_22
    s_mov_b32 s81, 57344
    s_mov_b32 s73, 34
    s_mul_i32 s72, s73, 28672
    s_add_u32 s72, s72, s75
    s_add_u32 m0, s81, 8192
    s_nop 0
    buffer_load_dwordx4 v252, s[76:79], s72 offen offset:0 lds
    s_add_u32 s72, s72, 6144
    buffer_load_dwordx4 v252, s[76:79], s72 offen offset:1024 lds
    s_add_u32 s72, s72, 6144
    buffer_load_dwordx4 v252, s[76:79], s72 offen offset:2048 lds
    s_add_u32 s72, s72, 6144
    buffer_load_dwordx4 v252, s[76:79], s72 offen offset:3072 lds
WBo_22:
    s_cmp_lg_u32 s3, 1
    s_cbranch_scc1 WBo_23
    s_mov_b32 s81, 57344
    s_mov_b32 s73, 35
    s_mul_i32 s72, s73, 28672
    s_add_u32 s72, s72, s75
    s_add_u32 m0, s81, 12288
    s_nop 0
    buffer_load_dwordx4 v252, s[76:79], s72 offen offset:0 lds
    s_add_u32 s72, s72, 6144
    buffer_load_dwordx4 v252, s[76:79], s72 offen offset:1024 lds
    s_add_u32 s72, s72, 6144
    buffer_load_dwordx4 v252, s[76:79], s72 offen offset:2048 lds
    s_add_u32 s72, s72, 6144
    buffer_load_dwordx4 v252, s[76:79], s72 offen offset:3072 lds
WBo_23:
    s_cmp_lg_u32 s3, 3
    s_cbranch_scc1 WBo_24
    s_mov_b32 s81, 57344
    s_mov_b32 s73, 38
    s_mul_i32 s72, s73, 28672
    s_add_u32 s72, s72, s75
    s_add_u32 m0, s81, 16384
    s_nop 0
    buffer_load_dwordx4 v252, s[76:79], s72 offen offset:0 lds
    s_add_u32 s72, s72, 6144
    buffer_load_dwordx4 v252, s[76:79], s72 offen offset:1024 lds
    s_add_u32 s72, s72, 6144
    buffer_load_dwordx4 v252, s[76:79], s72 offen offset:2048 lds
    s_add_u32 s72, s72, 6144
    buffer_load_dwordx4 v252, s[76:79], s72 offen offset:3072 lds
WBo_24:
    s_cmp_lg_u32 s3, 0
    s_cbranch_scc1 WBo_25
    s_mov_b32 s81, 57344
    s_mov_b32 s73, 39
    s_mul_i32 s72, s73, 28672
    s_add_u32 s72, s72, s75
    s_add_u32 m0, s81, 20480
    s_nop 0
    buffer_load_dwordx4 v252, s[76:79], s72 offen offset:0 lds
    s_add_u32 s72, s72, 6144
    buffer_load_dwordx4 v252, s[76:79], s72 offen offset:1024 lds
    s_add_u32 s72, s72, 6144
    buffer_load_dwordx4 v252, s[76:79], s72 offen offset:2048 lds
    s_add_u32 s72, s72, 6144
    buffer_load_dwordx4 v252, s[76:79], s72 offen offset:3072 lds
WBo_25:
    s_cmp_lg_u32 s3, 1
    s_cbranch_scc1 WBo_26
    s_mov_b32 s81, 57344
    s_mov_b32 s73, 42
    s_mul_i32 s72, s73, 28672
    s_add_u32 s72, s72, s75
    s_add_u32 m0, s81, 24576
    s_nop 0
    buffer_load_dwordx4 v252, s[76:79], s72 offen offset:0 lds
    s_add_u32 s72, s72, 6144
    buffer_load_dwordx4 v252, s[76:79], s72 offen offset:1024 lds
    s_add_u32 s72, s72, 6144
    buffer_load_dwordx4 v252, s[76:79], s72 offen offset:2048 lds
    s_add_u32 s72, s72, 6144
    buffer_load_dwordx4 v252, s[76:79], s72 offen offset:3072 lds
WBo_26:
WB_21:
    s_lshl_b32 s42, s32, 3
    s_lshl_b32 s37, s34, 2
    s_add_u32 s42, s42, s37
    s_add_u32 s36, s3, 0
    s_and_b32 s36, s36, 3
    s_mul_i32 s36, s36, 57344
    v_add_u32 v4, s36, v10
    s_add_u32 s36, s3, 1
    s_and_b32 s36, s36, 3
    s_mul_i32 s36, s36, 57344
    v_add_u32 v5, s36, v10
    s_add_u32 s36, s3, 2
    s_and_b32 s36, s36, 3
    s_mul_i32 s36, s36, 57344
    v_add_u32 v6, s36, v10
    s_add_u32 s36, s3, 3
    s_and_b32 s36, s36, 3
    s_mul_i32 s36, s36, 57344
    v_add_u32 v7, s36, v10
    s_mul_i32 s38, s42, 57344
    s_add_u32 s43, s38, 8388608
    s_lshl_b32 s50, s50, 10
    s_add_u32 s50, s50, s43
    s_lshl_b32 s51, s51, 10
    s_add_u32 s51, s51, s43
    s_lshl_b32 s52, s52, 10
    s_add_u32 s52, s52, s43
    s_lshl_b32 s53, s53, 10
    s_add_u32 s53, s53, s43
    s_lshl_b32 s54, s54, 10
    s_add_u32 s54, s54, s43
    s_lshl_b32 s55, s55, 10
    s_add_u32 s55, s55, s43
    s_lshl_b32 s56, s56, 10
    s_add_u32 s56, s56, s43
    s_lshl_b32 s57, s57, 10
    s_add_u32 s57, s57, s43
    s_lshl_b32 s58, s58, 10
    s_add_u32 s58, s58, s43
    s_lshl_b32 s59, s59, 10
    s_add_u32 s59, s59, s43
    s_lshl_b32 s60, s60, 10
    s_add_u32 s60, s60, s43
    s_lshl_b32 s61, s61, 10
    s_add_u32 s61, s61, s43
    s_lshl_b32 s62, s62, 10
    s_add_u32 s62, s62, s43
    s_lshl_b32 s63, s63, 10
    s_add_u32 s63, s63, s43
    s_cmp_lg_u32 s3, 2
    s_cbranch_scc1 OW_27
    v_min_u32 v2, 13, v1
    v_lshlrev_b32 v2, 2, v2
    s_lshl_b32 s47, s32, 9
    s_add_u32 s47, s47, 8323200
    s_waitcnt vmcnt(0)
    buffer_load_dword v0, v2, s[16:19], s47 offen sc1
    s_mov_b32 s38, 0
PLl_28:
    s_sleep 2
    buffer_load_dword v254, v2, s[16:19], s47 offen sc1
    s_waitcnt vmcnt(1)
    v_cmp_ne_u32 vcc, 1, v0
    s_cbranch_vccz PLk_29
    s_sleep 2
    buffer_load_dword v0, v2, s[16:19], s47 offen sc1
    s_waitcnt vmcnt(1)
    v_cmp_ne_u32 vcc, 1, v254
    s_cbranch_vccz PLk_29
    s_add_u32 s38, s38, 1
    s_cmp_lt_u32 s38, 300000
    s_cbranch_scc1 PLl_28
PLk_29:
OW_27:
    s_barrier
    buffer_load_dwordx4 v[32:35], v5, s[16:19], s50 offen sc1
    buffer_load_dwordx4 v[36:39], v5, s[16:19], s51 offen sc1
    buffer_load_dwordx4 v[40:43], v5, s[16:19], s52 offen sc1
    buffer_load_dwordx4 v[44:47], v5, s[16:19], s53 offen sc1
    buffer_load_dwordx4 v[48:51], v5, s[16:19], s54 offen sc1
    buffer_load_dwordx4 v[52:55], v5, s[16:19], s55 offen sc1
    buffer_load_dwordx4 v[56:59], v5, s[16:19], s56 offen sc1
    buffer_load_dwordx4 v[60:63], v5, s[16:19], s57 offen sc1
    buffer_load_dwordx4 v[64:67], v5, s[16:19], s58 offen sc1
    buffer_load_dwordx4 v[68:71], v5, s[16:19], s59 offen sc1
    buffer_load_dwordx4 v[72:75], v5, s[16:19], s60 offen sc1
    buffer_load_dwordx4 v[76:79], v5, s[16:19], s61 offen sc1
    buffer_load_dwordx4 v[80:83], v5, s[16:19], s62 offen sc1
    buffer_load_dwordx4 v[84:87], v5, s[16:19], s63 offen sc1
    s_add_u32 s36, s3, 1
    s_and_b32 s36, s36, 3
    s_mul_i32 s36, s36, 12288
    s_add_u32 s36, s36, 114688
    v_add_u32 v12, s36, v10
    s_add_u32 s36, s3, 2
    s_and_b32 s36, s36, 3
    s_mul_i32 s36, s36, 12288
    s_add_u32 s36, s36, 118784
    v_add_u32 v14, s36, v10
    s_add_u32 s36, s3, 3
    s_and_b32 s36, s36, 3
    s_mul_i32 s36, s36, 12288
    s_add_u32 s36, s36, 122880
    v_add_u32 v15, s36, v10
    s_waitcnt vmcnt(12)
    v_mfma_f32_16x16x32_bf16 v[176:179], a[0:3], v[32:35], 0
    buffer_load_dwordx4 v[88:91], v6, s[16:19], s50 offen sc1
    v_mfma_f32_16x16x32_bf16 v[180:183], a[4:7], v[32:35], 0
    v_mfma_f32_16x16x32_bf16 v[184:187], a[8:11], v[32:35], 0
    v_mfma_f32_16x16x32_bf16 v[188:191], a[12:15], v[32:35], 0
    v_mfma_f32_16x16x32_bf16 v[176:179], a[16:19], v[36:39], v[176:179]
    buffer_load_dwordx4 v[92:95], v6, s[16:19], s51 offen sc1
    v_mfma_f32_16x16x32_bf16 v[180:183], a[20:23], v[36:39], v[180:183]
    v_mfma_f32_16x16x32_bf16 v[184:187], a[24:27], v[36:39], v[184:187]
    v_mfma_f32_16x16x32_bf16 v[188:191], a[28:31], v[36:39], v[188:191]
    s_waitcnt vmcnt(12)
    v_mfma_f32_16x16x32_bf16 v[176:179], a[32:35], v[40:43], v[176:179]
    buffer_load_dwordx4 v[96:99], v6, s[16:19], s52 offen sc1
    v_mfma_f32_16x16x32_bf16 v[180:183], a[36:39], v[40:43], v[180:183]
    v_mfma_f32_16x16x32_bf16 v[184:187], a[40:43], v[40:43], v[184:187]
    v_mfma_f32_16x16x32_bf16 v[188:191], a[44:47], v[40:43], v[188:191]
    s_barrier
    v_mfma_f32_16x16x32_bf16 v[176:179], a[48:51], v[44:47], v[176:179]
    buffer_load_dwordx4 v[100:103], v6, s[16:19], s53 offen sc1
    v_mfma_f32_16x16x32_bf16 v[180:183], a[52:55], v[44:47], v[180:183]
    ds_read_b64_tr_b16 a[112:113], v144 offset:0
    v_mfma_f32_16x16x32_bf16 v[184:187], a[56:59], v[44:47], v[184:187]
    ds_read_b64_tr_b16 a[114:115], v144 offset:2048
    v_mfma_f32_16x16x32_bf16 v[188:191], a[60:63], v[44:47], v[188:191]
    ds_read_b64_tr_b16 a[116:117], v145 offset:0
    ds_read_b64_tr_b16 a[118:119], v145 offset:2048
    ds_read_b64_tr_b16 a[120:121], v146 offset:0
    ds_read_b64_tr_b16 a[122:123], v146 offset:2048
    ds_read_b64_tr_b16 a[124:125], v147 offset:0
    ds_read_b64_tr_b16 a[126:127], v147 offset:2048
    s_waitcnt vmcnt(12)
    v_mfma_f32_16x16x32_bf16 v[176:179], a[64:67], v[48:51], v[176:179]
    buffer_load_dwordx4 v[104:107], v6, s[16:19], s54 offen sc1
    v_mfma_f32_16x16x32_bf16 v[180:183], a[68:71], v[48:51], v[180:183]
    ds_read_b64_tr_b16 a[128:129], v144 offset:4096
    v_mfma_f32_16x16x32_bf16 v[184:187], a[72:75], v[48:51], v[184:187]
    ds_read_b64_tr_b16 a[130:131], v144 offset:6144
    v_mfma_f32_16x16x32_bf16 v[188:191], a[76:79], v[48:51], v[188:191]
    ds_read_b64_tr_b16 a[132:133], v145 offset:4096
    ds_read_b64_tr_b16 a[134:135], v145 offset:6144
    ds_read_b64_tr_b16 a[136:137], v146 offset:4096
    ds_read_b64_tr_b16 a[138:139], v146 offset:6144
    ds_read_b64_tr_b16 a[140:141], v147 offset:4096
    ds_read_b64_tr_b16 a[142:143], v147 offset:6144
    v_mfma_f32_16x16x32_bf16 v[176:179], a[80:83], v[52:55], v[176:179]
    buffer_load_dwordx4 v[108:111], v6, s[16:19], s55 offen sc1
    v_mfma_f32_16x16x32_bf16 v[180:183], a[84:87], v[52:55], v[180:183]
    ds_read_b64_tr_b16 a[144:145], v144 offset:8192
    v_mfma_f32_16x16x32_bf16 v[184:187], a[88:91], v[52:55], v[184:187]
    ds_read_b64_tr_b16 a[146:147], v144 offset:10240
    v_mfma_f32_16x16x32_bf16 v[188:191], a[92:95], v[52:55], v[188:191]
    ds_read_b64_tr_b16 a[148:149], v145 offset:8192
    ds_read_b64_tr_b16 a[150:151], v145 offset:10240
    ds_read_b64_tr_b16 a[152:153], v146 offset:8192
    ds_read_b64_tr_b16 a[154:155], v146 offset:10240
    ds_read_b64_tr_b16 a[156:157], v147 offset:8192
    ds_read_b64_tr_b16 a[158:159], v147 offset:10240
    s_waitcnt vmcnt(12)
    v_mfma_f32_16x16x32_bf16 v[176:179], a[96:99], v[56:59], v[176:179]
    buffer_load_dwordx4 v[32:35], v6, s[16:19], s56 offen sc1
    v_mfma_f32_16x16x32_bf16 v[180:183], a[100:103], v[56:59], v[180:183]
    ds_read_b64_tr_b16 a[160:161], v144 offset:12288
    v_mfma_f32_16x16x32_bf16 v[184:187], a[104:107], v[56:59], v[184:187]
    ds_read_b64_tr_b16 a[162:163], v144 offset:14336
    v_mfma_f32_16x16x32_bf16 v[188:191], a[108:111], v[56:59], v[188:191]
    ds_read_b64_tr_b16 a[164:165], v145 offset:12288
    ds_read_b64_tr_b16 a[166:167], v145 offset:14336
    ds_read_b64_tr_b16 a[168:169], v146 offset:12288
    ds_read_b64_tr_b16 a[170:171], v146 offset:14336
    ds_read_b64_tr_b16 a[172:173], v147 offset:12288
    ds_read_b64_tr_b16 a[174:175], v147 offset:14336
    s_waitcnt lgkmcnt(15)
    v_mfma_f32_16x16x32_bf16 v[176:179], a[112:115], v[60:63], v[176:179]
    buffer_load_dwordx4 v[36:39], v6, s[16:19], s57 offen sc1
    v_mfma_f32_16x16x32_bf16 v[180:183], a[116:119], v[60:63], v[180:183]
    ds_read_b64_tr_b16 a[176:177], v144 offset:16384
    v_mfma_f32_16x16x32_bf16 v[184:187], a[120:123], v[60:63], v[184:187]
    ds_read_b64_tr_b16 a[178:179], v144 offset:18432
    v_mfma_f32_16x16x32_bf16 v[188:191], a[124:127], v[60:63], v[188:191]
    ds_read_b64_tr_b16 a[180:181], v145 offset:16384
    ds_read_b64_tr_b16 a[182:183], v145 offset:18432
    ds_read_b64_tr_b16 a[184:185], v146 offset:16384
    ds_read_b64_tr_b16 a[186:187], v146 offset:18432
    ds_read_b64_tr_b16 a[188:189], v147 offset:16384
    ds_read_b64_tr_b16 a[190:191], v147 offset:18432
    s_waitcnt vmcnt(12)
    s_waitcnt lgkmcnt(15)
    v_mfma_f32_16x16x32_bf16 v[176:179], a[128:131], v[64:67], v[176:179]
    buffer_load_dwordx4 v[40:43], v6, s[16:19], s58 offen sc1
    v_mfma_f32_16x16x32_bf16 v[180:183], a[132:135], v[64:67], v[180:183]
    ds_read_b64_tr_b16 a[192:193], v144 offset:20480
    v_mfma_f32_16x16x32_bf16 v[184:187], a[136:139], v[64:67], v[184:187]
    ds_read_b64_tr_b16 a[194:195], v144 offset:22528
    v_mfma_f32_16x16x32_bf16 v[188:191], a[140:143], v[64:67], v[188:191]
    ds_read_b64_tr_b16 a[196:197], v145 offset:20480
    ds_read_b64_tr_b16 a[198:199], v145 offset:22528
    ds_read_b64_tr_b16 a[200:201], v146 offset:20480
    ds_read_b64_tr_b16 a[202:203], v146 offset:22528
    ds_read_b64_tr_b16 a[204:205], v147 offset:20480
    ds_read_b64_tr_b16 a[206:207], v147 offset:22528
    s_waitcnt lgkmcnt(15)
    v_mfma_f32_16x16x32_bf16 v[176:179], a[144:147], v[68:71], v[176:179]
    buffer_load_dwordx4 v[44:47], v6, s[16:19], s59 offen sc1
    v_mfma_f32_16x16x32_bf16 v[180:183], a[148:151], v[68:71], v[180:183]
    ds_read_b64_tr_b16 a[208:209], v144 offset:24576
    v_mfma_f32_16x16x32_bf16 v[184:187], a[152:155], v[68:71], v[184:187]
    ds_read_b64_tr_b16 a[210:211], v144 offset:26624
    v_mfma_f32_16x16x32_bf16 v[188:191], a[156:159], v[68:71], v[188:191]
    ds_read_b64_tr_b16 a[212:213], v145 offset:24576
    ds_read_b64_tr_b16 a[214:215], v145 offset:26624
    ds_read_b64_tr_b16 a[216:217], v146 offset:24576
    ds_read_b64_tr_b16 a[218:219], v146 offset:26624
    ds_read_b64_tr_b16 a[220:221], v147 offset:24576
    ds_read_b64_tr_b16 a[222:223], v147 offset:26624
    s_waitcnt vmcnt(12)
    s_waitcnt lgkmcnt(15)
    v_mfma_f32_16x16x32_bf16 v[176:179], a[160:163], v[72:75], v[176:179]
    buffer_load_dwordx4 v[48:51], v6, s[16:19], s60 offen sc1
    v_mfma_f32_16x16x32_bf16 v[180:183], a[164:167], v[72:75], v[180:183]
    v_mfma_f32_16x16x32_bf16 v[184:187], a[168:171], v[72:75], v[184:187]
    v_mfma_f32_16x16x32_bf16 v[188:191], a[172:175], v[72:75], v[188:191]
    s_waitcnt lgkmcnt(15)
    v_mfma_f32_16x16x32_bf16 v[176:179], a[176:179], v[76:79], v[176:179]
    buffer_load_dwordx4 v[52:55], v6, s[16:19], s61 offen sc1
    v_mfma_f32_16x16x32_bf16 v[180:183], a[180:183], v[76:79], v[180:183]
    v_mfma_f32_16x16x32_bf16 v[184:187], a[184:187], v[76:79], v[184:187]
    v_mfma_f32_16x16x32_bf16 v[188:191], a[188:191], v[76:79], v[188:191]
    s_waitcnt vmcnt(12)
    s_waitcnt lgkmcnt(8)
    v_mfma_f32_16x16x32_bf16 v[176:179], a[192:195], v[80:83], v[176:179]
    buffer_load_dwordx4 v[56:59], v6, s[16:19], s62 offen sc1
    v_mfma_f32_16x16x32_bf16 v[180:183], a[196:199], v[80:83], v[180:183]
    v_mfma_f32_16x16x32_bf16 v[184:187], a[200:203], v[80:83], v[184:187]
    v_mfma_f32_16x16x32_bf16 v[188:191], a[204:207], v[80:83], v[188:191]
    s_waitcnt lgkmcnt(0)
    v_mfma_f32_16x16x32_bf16 v[176:179], a[208:211], v[84:87], v[176:179]
    buffer_load_dwordx4 v[60:63], v6, s[16:19], s63 offen sc1
    v_mfma_f32_16x16x32_bf16 v[180:183], a[212:215], v[84:87], v[180:183]
    v_mfma_f32_16x16x32_bf16 v[184:187], a[216:219], v[84:87], v[184:187]
    v_mfma_f32_16x16x32_bf16 v[188:191], a[220:223], v[84:87], v[188:191]
    s_waitcnt vmcnt(12)
    v_mfma_f32_16x16x32_bf16 v[192:195], a[0:3], v[88:91], 0
    buffer_load_dwordx4 v[64:67], v7, s[16:19], s50 offen sc1
    v_mfma_f32_16x16x32_bf16 v[196:199], a[4:7], v[88:91], 0
    v_mfma_f32_16x16x32_bf16 v[200:203], a[8:11], v[88:91], 0
    v_mfma_f32_16x16x32_bf16 v[204:207], a[12:15], v[88:91], 0
    v_mfma_f32_16x16x32_bf16 v[192:195], a[16:19], v[92:95], v[192:195]
    buffer_load_dwordx4 v[68:71], v7, s[16:19], s51 offen sc1
    v_mfma_f32_16x16x32_bf16 v[196:199], a[20:23], v[92:95], v[196:199]
    v_mfma_f32_16x16x32_bf16 v[200:203], a[24:27], v[92:95], v[200:203]
    v_mfma_f32_16x16x32_bf16 v[204:207], a[28:31], v[92:95], v[204:207]
    s_waitcnt vmcnt(12)
    v_mfma_f32_16x16x32_bf16 v[192:195], a[32:35], v[96:99], v[192:195]
    buffer_load_dwordx4 v[72:75], v7, s[16:19], s52 offen sc1
    v_mfma_f32_16x16x32_bf16 v[196:199], a[36:39], v[96:99], v[196:199]
    ds_write_b128 v12, v[176:179] offset:0
    v_mfma_f32_16x16x32_bf16 v[200:203], a[40:43], v[96:99], v[200:203]
    v_mfma_f32_16x16x32_bf16 v[204:207], a[44:47], v[96:99], v[204:207]
    v_mfma_f32_16x16x32_bf16 v[192:195], a[48:51], v[100:103], v[192:195]
    buffer_load_dwordx4 v[76:79], v7, s[16:19], s53 offen sc1
    v_mfma_f32_16x16x32_bf16 v[196:199], a[52:55], v[100:103], v[196:199]
    ds_write_b128 v12, v[180:183] offset:1024
    v_mfma_f32_16x16x32_bf16 v[200:203], a[56:59], v[100:103], v[200:203]
    v_mfma_f32_16x16x32_bf16 v[204:207], a[60:63], v[100:103], v[204:207]
    s_waitcnt vmcnt(12)
    v_mfma_f32_16x16x32_bf16 v[192:195], a[64:67], v[104:107], v[192:195]
    buffer_load_dwordx4 v[80:83], v7, s[16:19], s54 offen sc1
    v_mfma_f32_16x16x32_bf16 v[196:199], a[68:71], v[104:107], v[196:199]
    ds_write_b128 v12, v[184:187] offset:2048
    v_mfma_f32_16x16x32_bf16 v[200:203], a[72:75], v[104:107], v[200:203]
    v_mfma_f32_16x16x32_bf16 v[204:207], a[76:79], v[104:107], v[204:207]
    v_mfma_f32_16x16x32_bf16 v[192:195], a[80:83], v[108:111], v[192:195]
    buffer_load_dwordx4 v[84:87], v7, s[16:19], s55 offen sc1
    v_mfma_f32_16x16x32_bf16 v[196:199], a[84:87], v[108:111], v[196:199]
    ds_write_b128 v12, v[188:191] offset:3072
    v_mfma_f32_16x16x32_bf16 v[200:203], a[88:91], v[108:111], v[200:203]
    v_mfma_f32_16x16x32_bf16 v[204:207], a[92:95], v[108:111], v[204:207]
    s_waitcnt vmcnt(12)
    v_mfma_f32_16x16x32_bf16 v[192:195], a[96:99], v[32:35], v[192:195]
    buffer_load_dwordx4 v[88:91], v7, s[16:19], s56 offen sc1
    v_mfma_f32_16x16x32_bf16 v[196:199], a[100:103], v[32:35], v[196:199]
    v_mfma_f32_16x16x32_bf16 v[200:203], a[104:107], v[32:35], v[200:203]
    v_mfma_f32_16x16x32_bf16 v[204:207], a[108:111], v[32:35], v[204:207]
    v_mfma_f32_16x16x32_bf16 v[192:195], a[112:115], v[36:39], v[192:195]
    buffer_load_dwordx4 v[92:95], v7, s[16:19], s57 offen sc1
    v_mfma_f32_16x16x32_bf16 v[196:199], a[116:119], v[36:39], v[196:199]
    v_mfma_f32_16x16x32_bf16 v[200:203], a[120:123], v[36:39], v[200:203]
    v_mfma_f32_16x16x32_bf16 v[204:207], a[124:127], v[36:39], v[204:207]
    s_waitcnt vmcnt(12)
    v_mfma_f32_16x16x32_bf16 v[192:195], a[128:131], v[40:43], v[192:195]
    buffer_load_dwordx4 v[96:99], v7, s[16:19], s58 offen sc1
    v_mfma_f32_16x16x32_bf16 v[196:199], a[132:135], v[40:43], v[196:199]
    v_mfma_f32_16x16x32_bf16 v[200:203], a[136:139], v[40:43], v[200:203]
    v_mfma_f32_16x16x32_bf16 v[204:207], a[140:143], v[40:43], v[204:207]
    v_mfma_f32_16x16x32_bf16 v[192:195], a[144:147], v[44:47], v[192:195]
    buffer_load_dwordx4 v[100:103], v7, s[16:19], s59 offen sc1
    v_mfma_f32_16x16x32_bf16 v[196:199], a[148:151], v[44:47], v[196:199]
    v_mfma_f32_16x16x32_bf16 v[200:203], a[152:155], v[44:47], v[200:203]
    v_mfma_f32_16x16x32_bf16 v[204:207], a[156:159], v[44:47], v[204:207]
    s_waitcnt vmcnt(12)
    v_mfma_f32_16x16x32_bf16 v[192:195], a[160:163], v[48:51], v[192:195]
    buffer_load_dwordx4 v[104:107], v7, s[16:19], s60 offen sc1
    v_mfma_f32_16x16x32_bf16 v[196:199], a[164:167], v[48:51], v[196:199]
    v_mfma_f32_16x16x32_bf16 v[200:203], a[168:171], v[48:51], v[200:203]
    v_mfma_f32_16x16x32_bf16 v[204:207], a[172:175], v[48:51], v[204:207]
    v_mfma_f32_16x16x32_bf16 v[192:195], a[176:179], v[52:55], v[192:195]
    buffer_load_dwordx4 v[108:111], v7, s[16:19], s61 offen sc1
    v_mfma_f32_16x16x32_bf16 v[196:199], a[180:183], v[52:55], v[196:199]
    v_mfma_f32_16x16x32_bf16 v[200:203], a[184:187], v[52:55], v[200:203]
    v_mfma_f32_16x16x32_bf16 v[204:207], a[188:191], v[52:55], v[204:207]
    s_waitcnt vmcnt(12)
    v_mfma_f32_16x16x32_bf16 v[192:195], a[192:195], v[56:59], v[192:195]
    buffer_load_dwordx4 v[32:35], v7, s[16:19], s62 offen sc1
    v_mfma_f32_16x16x32_bf16 v[196:199], a[196:199], v[56:59], v[196:199]
    v_mfma_f32_16x16x32_bf16 v[200:203], a[200:203], v[56:59], v[200:203]
    v_mfma_f32_16x16x32_bf16 v[204:207], a[204:207], v[56:59], v[204:207]
    v_mfma_f32_16x16x32_bf16 v[192:195], a[208:211], v[60:63], v[192:195]
    buffer_load_dwordx4 v[36:39], v7, s[16:19], s63 offen sc1
    v_mfma_f32_16x16x32_bf16 v[196:199], a[212:215], v[60:63], v[196:199]
    v_mfma_f32_16x16x32_bf16 v[200:203], a[216:219], v[60:63], v[200:203]
    v_mfma_f32_16x16x32_bf16 v[204:207], a[220:223], v[60:63], v[204:207]
    s_waitcnt vmcnt(12)
    v_mfma_f32_16x16x32_bf16 v[208:211], a[0:3], v[64:67], 0
    buffer_load_dwordx4 v[40:43], v4, s[16:19], s50 offen sc1
    v_mfma_f32_16x16x32_bf16 v[212:215], a[4:7], v[64:67], 0
    v_mfma_f32_16x16x32_bf16 v[216:219], a[8:11], v[64:67], 0
    v_mfma_f32_16x16x32_bf16 v[220:223], a[12:15], v[64:67], 0
    v_mfma_f32_16x16x32_bf16 v[208:211], a[16:19], v[68:71], v[208:211]
    buffer_load_dwordx4 v[44:47], v4, s[16:19], s51 offen sc1
    v_mfma_f32_16x16x32_bf16 v[212:215], a[20:23], v[68:71], v[212:215]
    v_mfma_f32_16x16x32_bf16 v[216:219], a[24:27], v[68:71], v[216:219]
    v_mfma_f32_16x16x32_bf16 v[220:223], a[28:31], v[68:71], v[220:223]
    s_waitcnt vmcnt(12)
    v_mfma_f32_16x16x32_bf16 v[208:211], a[32:35], v[72:75], v[208:211]
    buffer_load_dwordx4 v[48:51], v4, s[16:19], s52 offen sc1
    v_mfma_f32_16x16x32_bf16 v[212:215], a[36:39], v[72:75], v[212:215]
    ds_write_b128 v14, v[192:195] offset:0
    v_mfma_f32_16x16x32_bf16 v[216:219], a[40:43], v[72:75], v[216:219]
    v_mfma_f32_16x16x32_bf16 v[220:223], a[44:47], v[72:75], v[220:223]
    v_mfma_f32_16x16x32_bf16 v[208:211], a[48:51], v[76:79], v[208:211]
    buffer_load_dwordx4 v[52:55], v4, s[16:19], s53 offen sc1
    v_mfma_f32_16x16x32_bf16 v[212:215], a[52:55], v[76:79], v[212:215]
    ds_write_b128 v14, v[196:199] offset:1024
    v_mfma_f32_16x16x32_bf16 v[216:219], a[56:59], v[76:79], v[216:219]
    v_mfma_f32_16x16x32_bf16 v[220:223], a[60:63], v[76:79], v[220:223]
    s_waitcnt vmcnt(12)
    v_mfma_f32_16x16x32_bf16 v[208:211], a[64:67], v[80:83], v[208:211]
    buffer_load_dwordx4 v[56:59], v4, s[16:19], s54 offen sc1
    v_mfma_f32_16x16x32_bf16 v[212:215], a[68:71], v[80:83], v[212:215]
    ds_write_b128 v14, v[200:203] offset:2048
    v_mfma_f32_16x16x32_bf16 v[216:219], a[72:75], v[80:83], v[216:219]
    v_mfma_f32_16x16x32_bf16 v[220:223], a[76:79], v[80:83], v[220:223]
    v_mfma_f32_16x16x32_bf16 v[208:211], a[80:83], v[84:87], v[208:211]
    buffer_load_dwordx4 v[60:63], v4, s[16:19], s55 offen sc1
    v_mfma_f32_16x16x32_bf16 v[212:215], a[84:87], v[84:87], v[212:215]
    ds_write_b128 v14, v[204:207] offset:3072
    v_mfma_f32_16x16x32_bf16 v[216:219], a[88:91], v[84:87], v[216:219]
    v_mfma_f32_16x16x32_bf16 v[220:223], a[92:95], v[84:87], v[220:223]
    s_waitcnt vmcnt(12)
    v_mfma_f32_16x16x32_bf16 v[208:211], a[96:99], v[88:91], v[208:211]
    buffer_load_dwordx4 v[64:67], v4, s[16:19], s56 offen sc1
    v_mfma_f32_16x16x32_bf16 v[212:215], a[100:103], v[88:91], v[212:215]
    v_mfma_f32_16x16x32_bf16 v[216:219], a[104:107], v[88:91], v[216:219]
    v_mfma_f32_16x16x32_bf16 v[220:223], a[108:111], v[88:91], v[220:223]
    v_mfma_f32_16x16x32_bf16 v[208:211], a[112:115], v[92:95], v[208:211]
    buffer_load_dwordx4 v[68:71], v4, s[16:19], s57 offen sc1
    v_mfma_f32_16x16x32_bf16 v[212:215], a[116:119], v[92:95], v[212:215]
    v_mfma_f32_16x16x32_bf16 v[216:219], a[120:123], v[92:95], v[216:219]
    v_mfma_f32_16x16x32_bf16 v[220:223], a[124:127], v[92:95], v[220:223]
    s_waitcnt vmcnt(12)
    v_mfma_f32_16x16x32_bf16 v[208:211], a[128:131], v[96:99], v[208:211]
    buffer_load_dwordx4 v[72:75], v4, s[16:19], s58 offen sc1
    v_mfma_f32_16x16x32_bf16 v[212:215], a[132:135], v[96:99], v[212:215]
    v_mfma_f32_16x16x32_bf16 v[216:219], a[136:139], v[96:99], v[216:219]
    v_mfma_f32_16x16x32_bf16 v[220:223], a[140:143], v[96:99], v[220:223]
    v_mfma_f32_16x16x32_bf16 v[208:211], a[144:147], v[100:103], v[208:211]
    buffer_load_dwordx4 v[76:79], v4, s[16:19], s59 offen sc1
    v_mfma_f32_16x16x32_bf16 v[212:215], a[148:151], v[100:103], v[212:215]
    v_mfma_f32_16x16x32_bf16 v[216:219], a[152:155], v[100:103], v[216:219]
    v_mfma_f32_16x16x32_bf16 v[220:223], a[156:159], v[100:103], v[220:223]
    s_waitcnt vmcnt(12)
    v_mfma_f32_16x16x32_bf16 v[208:211], a[160:163], v[104:107], v[208:211]
    buffer_load_dwordx4 v[80:83], v4, s[16:19], s60 offen sc1
    v_mfma_f32_16x16x32_bf16 v[212:215], a[164:167], v[104:107], v[212:215]
    v_mfma_f32_16x16x32_bf16 v[216:219], a[168:171], v[104:107], v[216:219]
    v_mfma_f32_16x16x32_bf16 v[220:223], a[172:175], v[104:107], v[220:223]
    v_mfma_f32_16x16x32_bf16 v[208:211], a[176:179], v[108:111], v[208:211]
    buffer_load_dwordx4 v[84:87], v4, s[16:19], s61 offen sc1
    v_mfma_f32_16x16x32_bf16 v[212:215], a[180:183], v[108:111], v[212:215]
    v_mfma_f32_16x16x32_bf16 v[216:219], a[184:187], v[108:111], v[216:219]
    v_mfma_f32_16x16x32_bf16 v[220:223], a[188:191], v[108:111], v[220:223]
    s_waitcnt vmcnt(12)
    v_mfma_f32_16x16x32_bf16 v[208:211], a[192:195], v[32:35], v[208:211]
    buffer_load_dwordx4 v[88:91], v4, s[16:19], s62 offen sc1
    v_mfma_f32_16x16x32_bf16 v[212:215], a[196:199], v[32:35], v[212:215]
    v_mfma_f32_16x16x32_bf16 v[216:219], a[200:203], v[32:35], v[216:219]
    v_mfma_f32_16x16x32_bf16 v[220:223], a[204:207], v[32:35], v[220:223]
    v_mfma_f32_16x16x32_bf16 v[208:211], a[208:211], v[36:39], v[208:211]
    buffer_load_dwordx4 v[92:95], v4, s[16:19], s63 offen sc1
    v_mfma_f32_16x16x32_bf16 v[212:215], a[212:215], v[36:39], v[212:215]
    v_mfma_f32_16x16x32_bf16 v[216:219], a[216:219], v[36:39], v[216:219]
    v_mfma_f32_16x16x32_bf16 v[220:223], a[220:223], v[36:39], v[220:223]
    s_waitcnt vmcnt(12)
    v_mfma_f32_16x16x32_bf16 v[160:163], a[0:3], v[40:43], 0
    v_mfma_f32_16x16x32_bf16 v[164:167], a[4:7], v[40:43], 0
    v_mfma_f32_16x16x32_bf16 v[168:171], a[8:11], v[40:43], 0
    v_mfma_f32_16x16x32_bf16 v[172:175], a[12:15], v[40:43], 0
    v_mfma_f32_16x16x32_bf16 v[160:163], a[16:19], v[44:47], v[160:163]
    v_mfma_f32_16x16x32_bf16 v[164:167], a[20:23], v[44:47], v[164:167]
    v_mfma_f32_16x16x32_bf16 v[168:171], a[24:27], v[44:47], v[168:171]
    v_mfma_f32_16x16x32_bf16 v[172:175], a[28:31], v[44:47], v[172:175]
    s_waitcnt vmcnt(10)
    v_mfma_f32_16x16x32_bf16 v[160:163], a[32:35], v[48:51], v[160:163]
    ds_write_b128 v15, v[208:211] offset:0
    v_mfma_f32_16x16x32_bf16 v[164:167], a[36:39], v[48:51], v[164:167]
    s_mul_i32 s36, s3, 12288
    v_mfma_f32_16x16x32_bf16 v[168:171], a[40:43], v[48:51], v[168:171]
    s_add_u32 s36, s36, 114688
    v_mfma_f32_16x16x32_bf16 v[172:175], a[44:47], v[48:51], v[172:175]
    v_add_u32 v11, s36, v10
    v_mfma_f32_16x16x32_bf16 v[160:163], a[48:51], v[52:55], v[160:163]
    ds_write_b128 v15, v[212:215] offset:1024
    v_mfma_f32_16x16x32_bf16 v[164:167], a[52:55], v[52:55], v[164:167]
    v_lshlrev_b32 v112, 16, v240
    v_mfma_f32_16x16x32_bf16 v[168:171], a[56:59], v[52:55], v[168:171]
    v_and_b32 v113, 0xffff0000, v240
    v_mfma_f32_16x16x32_bf16 v[172:175], a[60:63], v[52:55], v[172:175]
    v_lshlrev_b32 v114, 16, v241
    s_waitcnt vmcnt(8)
    v_mfma_f32_16x16x32_bf16 v[160:163], a[64:67], v[56:59], v[160:163]
    ds_write_b128 v15, v[216:219] offset:2048
    v_mfma_f32_16x16x32_bf16 v[164:167], a[68:71], v[56:59], v[164:167]
    v_and_b32 v115, 0xffff0000, v241
    v_mfma_f32_16x16x32_bf16 v[168:171], a[72:75], v[56:59], v[168:171]
    v_lshlrev_b32 v116, 16, v242
    v_mfma_f32_16x16x32_bf16 v[172:175], a[76:79], v[56:59], v[172:175]
    v_and_b32 v117, 0xffff0000, v242
    v_mfma_f32_16x16x32_bf16 v[160:163], a[80:83], v[60:63], v[160:163]
    ds_write_b128 v15, v[220:223] offset:3072
    v_mfma_f32_16x16x32_bf16 v[164:167], a[84:87], v[60:63], v[164:167]
    v_lshlrev_b32 v118, 16, v243
    v_mfma_f32_16x16x32_bf16 v[168:171], a[88:91], v[60:63], v[168:171]
    v_and_b32 v119, 0xffff0000, v243
    v_mfma_f32_16x16x32_bf16 v[172:175], a[92:95], v[60:63], v[172:175]
    v_lshlrev_b32 v120, 16, v244
    s_waitcnt vmcnt(6)
    v_mfma_f32_16x16x32_bf16 v[160:163], a[96:99], v[64:67], v[160:163]
    v_and_b32 v121, 0xffff0000, v244
    v_mfma_f32_16x16x32_bf16 v[164:167], a[100:103], v[64:67], v[164:167]
    v_lshlrev_b32 v122, 16, v245
    v_mfma_f32_16x16x32_bf16 v[168:171], a[104:107], v[64:67], v[168:171]
    v_and_b32 v123, 0xffff0000, v245
    v_mfma_f32_16x16x32_bf16 v[172:175], a[108:111], v[64:67], v[172:175]
    v_mfma_f32_16x16x32_bf16 v[160:163], a[112:115], v[68:71], v[160:163]
    v_lshlrev_b32 v124, 16, v246
    v_mfma_f32_16x16x32_bf16 v[164:167], a[116:119], v[68:71], v[164:167]
    v_and_b32 v125, 0xffff0000, v246
    v_mfma_f32_16x16x32_bf16 v[168:171], a[120:123], v[68:71], v[168:171]
    v_lshlrev_b32 v126, 16, v247
    v_mfma_f32_16x16x32_bf16 v[172:175], a[124:127], v[68:71], v[172:175]
    s_waitcnt vmcnt(4)
    v_mfma_f32_16x16x32_bf16 v[160:163], a[128:131], v[72:75], v[160:163]
    v_and_b32 v127, 0xffff0000, v247
    v_mfma_f32_16x16x32_bf16 v[164:167], a[132:135], v[72:75], v[164:167]
    v_and_b32 v13, 15, v1
    v_mfma_f32_16x16x32_bf16 v[168:171], a[136:139], v[72:75], v[168:171]
    s_lshl_b32 s37, s40, 4
    v_mfma_f32_16x16x32_bf16 v[172:175], a[140:143], v[72:75], v[172:175]
    v_mfma_f32_16x16x32_bf16 v[160:163], a[144:147], v[76:79], v[160:163]
    v_add_u32 v13, s37, v13
    v_mfma_f32_16x16x32_bf16 v[164:167], a[148:151], v[76:79], v[164:167]
    s_movk_i32 s38, 896
    v_mfma_f32_16x16x32_bf16 v[168:171], a[152:155], v[76:79], v[168:171]
    v_bfe_u32 v2, v1, 4, 1
    v_mfma_f32_16x16x32_bf16 v[172:175], a[156:159], v[76:79], v[172:175]
    s_waitcnt vmcnt(2)
    v_mfma_f32_16x16x32_bf16 v[160:163], a[160:163], v[80:83], v[160:163]
    v_lshlrev_b32 v2, 5, v2
    v_mfma_f32_16x16x32_bf16 v[164:167], a[164:167], v[80:83], v[164:167]
    v_mad_u32_u24 v13, v13, s38, v2
    v_mfma_f32_16x16x32_bf16 v[168:171], a[168:171], v[80:83], v[168:171]
    v_lshrrev_b32 v2, 5, v1
    v_mfma_f32_16x16x32_bf16 v[172:175], a[172:175], v[80:83], v[172:175]
    v_mfma_f32_16x16x32_bf16 v[160:163], a[176:179], v[84:87], v[160:163]
    v_lshl_add_u32 v13, v2, 4, v13
    v_mfma_f32_16x16x32_bf16 v[164:167], a[180:183], v[84:87], v[164:167]
    s_lshl_b32 s37, s35, 7
    v_mfma_f32_16x16x32_bf16 v[168:171], a[184:187], v[84:87], v[168:171]
    v_add_u32 v13, s37, v13
    v_mfma_f32_16x16x32_bf16 v[172:175], a[188:191], v[84:87], v[172:175]
    s_waitcnt vmcnt(0)
    v_mfma_f32_16x16x32_bf16 v[160:163], a[192:195], v[88:91], v[160:163]
    v_mfma_f32_16x16x32_bf16 v[164:167], a[196:199], v[88:91], v[164:167]
    v_mfma_f32_16x16x32_bf16 v[168:171], a[200:203], v[88:91], v[168:171]
    v_mfma_f32_16x16x32_bf16 v[172:175], a[204:207], v[88:91], v[172:175]
    v_mfma_f32_16x16x32_bf16 v[160:163], a[208:211], v[92:95], v[160:163]
    v_mfma_f32_16x16x32_bf16 v[164:167], a[212:215], v[92:95], v[164:167]
    v_mfma_f32_16x16x32_bf16 v[168:171], a[216:219], v[92:95], v[168:171]
    v_mfma_f32_16x16x32_bf16 v[172:175], a[220:223], v[92:95], v[172:175]
    s_waitcnt lgkmcnt(0)
    s_barrier
    ds_read_b128 v[32:35], v11 offset:0
    ds_read_b128 v[36:39], v11 offset:1024
    ds_read_b128 v[40:43], v11 offset:2048
    ds_read_b128 v[44:47], v11 offset:3072
    ds_read_b128 v[48:51], v11 offset:4096
    ds_read_b128 v[52:55], v11 offset:5120
    ds_read_b128 v[56:59], v11 offset:6144
    ds_read_b128 v[60:63], v11 offset:7168
    ds_read_b128 v[64:67], v11 offset:8192
    ds_read_b128 v[68:71], v11 offset:9216
    ds_read_b128 v[72:75], v11 offset:10240
    ds_read_b128 v[76:79], v11 offset:11264
    s_waitcnt lgkmcnt(8)
    v_pk_add_f32 v[160:161], v[160:161], v[32:33]
    v_pk_add_f32 v[162:163], v[162:163], v[34:35]
    v_pk_add_f32 v[164:165], v[164:165], v[36:37]
    v_pk_add_f32 v[166:167], v[166:167], v[38:39]
    v_pk_add_f32 v[168:169], v[168:169], v[40:41]
    v_pk_add_f32 v[170:171], v[170:171], v[42:43]
    v_pk_add_f32 v[172:173], v[172:173], v[44:45]
    v_pk_add_f32 v[174:175], v[174:175], v[46:47]
    s_waitcnt lgkmcnt(4)
    v_pk_add_f32 v[160:161], v[160:161], v[48:49]
    v_pk_add_f32 v[162:163], v[162:163], v[50:51]
    v_pk_add_f32 v[164:165], v[164:165], v[52:53]
    v_pk_add_f32 v[166:167], v[166:167], v[54:55]
    v_pk_add_f32 v[168:169], v[168:169], v[56:57]
    v_pk_add_f32 v[170:171], v[170:171], v[58:59]
    v_pk_add_f32 v[172:173], v[172:173], v[60:61]
    v_pk_add_f32 v[174:175], v[174:175], v[62:63]
    s_waitcnt lgkmcnt(0)
    v_pk_add_f32 v[160:161], v[160:161], v[64:65]
    v_pk_add_f32 v[162:163], v[162:163], v[66:67]
    v_pk_add_f32 v[164:165], v[164:165], v[68:69]
    v_pk_add_f32 v[166:167], v[166:167], v[70:71]
    v_pk_add_f32 v[168:169], v[168:169], v[72:73]
    v_pk_add_f32 v[170:171], v[170:171], v[74:75]
    v_pk_add_f32 v[172:173], v[172:173], v[76:77]
    v_pk_add_f32 v[174:175], v[174:175], v[78:79]
    v_pk_fma_f32 v[160:161], v[160:161], v[248:249], v[112:113] op_sel:[0,1,0] op_sel_hi:[1,1,1]
    v_pk_fma_f32 v[162:163], v[162:163], v[248:249], v[114:115] op_sel:[0,1,0] op_sel_hi:[1,1,1]
    v_pk_fma_f32 v[164:165], v[164:165], v[248:249], v[116:117] op_sel:[0,1,0] op_sel_hi:[1,1,1]
    v_pk_fma_f32 v[166:167], v[166:167], v[248:249], v[118:119] op_sel:[0,1,0] op_sel_hi:[1,1,1]
    v_pk_fma_f32 v[168:169], v[168:169], v[248:249], v[120:121] op_sel:[0,1,0] op_sel_hi:[1,1,1]
    v_pk_fma_f32 v[170:171], v[170:171], v[248:249], v[122:123] op_sel:[0,1,0] op_sel_hi:[1,1,1]
    v_pk_fma_f32 v[172:173], v[172:173], v[248:249], v[124:125] op_sel:[0,1,0] op_sel_hi:[1,1,1]
    v_pk_fma_f32 v[174:175], v[174:175], v[248:249], v[126:127] op_sel:[0,1,0] op_sel_hi:[1,1,1]
    v_cvt_pk_bf16_f32 v96, v160, v161
    v_cvt_pk_bf16_f32 v97, v162, v163
    v_cvt_pk_bf16_f32 v98, v164, v165
    v_cvt_pk_bf16_f32 v99, v166, v167
    v_cvt_pk_bf16_f32 v100, v168, v169
    v_cvt_pk_bf16_f32 v101, v170, v171
    v_cvt_pk_bf16_f32 v102, v172, v173
    v_cvt_pk_bf16_f32 v103, v174, v175
    v_permlane16_swap_b32 v96, v98
    v_permlane16_swap_b32 v97, v99
    v_permlane16_swap_b32 v100, v102
    v_permlane16_swap_b32 v101, v103
    buffer_store_dwordx4 v[96:99], v13, s[20:23], 0 offen offset:0
    buffer_store_dwordx4 v[100:103], v13, s[20:23], 0 offen offset:64
    s_branch K_tail
K_pf:
    s_lshr_b32 s40, s2, 6
    s_mov_b32 s41, s3
    v_lshrrev_b32 v14, 5, v1
    s_lshl_b32 s36, s41, 1
    v_add_u32 v14, s36, v14
    v_min_u32 v14, 6, v14
    v_lshlrev_b32 v14, 7, v14
    v_and_b32 v13, 31, v1
    s_movk_i32 s38, 896
    v_mad_u32_u24 v13, v13, s38, v14
    s_mul_i32 s36, s40, 7
    s_add_u32 s36, s36, 0
    s_lshr_b32 s37, s36, 1
    s_lshl_b32 s37, s37, 2
    s_and_b32 s36, s36, 1
    s_add_u32 s37, s37, s36
    s_add_u32 s37, s37, 0
    s_mul_i32 s37, s37, 28672
    buffer_load_dword v20, v13, s[76:79], s37 offen
    s_mul_i32 s36, s40, 7
    s_add_u32 s36, s36, 1
    s_lshr_b32 s37, s36, 1
    s_lshl_b32 s37, s37, 2
    s_and_b32 s36, s36, 1
    s_add_u32 s37, s37, s36
    s_add_u32 s37, s37, 0
    s_mul_i32 s37, s37, 28672
    buffer_load_dword v21, v13, s[76:79], s37 offen
    s_mul_i32 s36, s40, 7
    s_add_u32 s36, s36, 2
    s_lshr_b32 s37, s36, 1
    s_lshl_b32 s37, s37, 2
    s_and_b32 s36, s36, 1
    s_add_u32 s37, s37, s36
    s_add_u32 s37, s37, 0
    s_mul_i32 s37, s37, 28672
    buffer_load_dword v22, v13, s[76:79], s37 offen
    s_mul_i32 s36, s40, 7
    s_add_u32 s36, s36, 3
    s_lshr_b32 s37, s36, 1
    s_lshl_b32 s37, s37, 2
    s_and_b32 s36, s36, 1
    s_add_u32 s37, s37, s36
    s_add_u32 s37, s37, 0
    s_mul_i32 s37, s37, 28672
    buffer_load_dword v23, v13, s[76:79], s37 offen
    s_mul_i32 s36, s40, 7
    s_add_u32 s36, s36, 4
    s_lshr_b32 s37, s36, 1
    s_lshl_b32 s37, s37, 2
    s_and_b32 s36, s36, 1
    s_add_u32 s37, s37, s36
    s_add_u32 s37, s37, 0
    s_mul_i32 s37, s37, 28672
    buffer_load_dword v24, v13, s[76:79], s37 offen
    s_mul_i32 s36, s40, 7
    s_add_u32 s36, s36, 5
    s_lshr_b32 s37, s36, 1
    s_lshl_b32 s37, s37, 2
    s_and_b32 s36, s36, 1
    s_add_u32 s37, s37, s36
    s_add_u32 s37, s37, 0
    s_mul_i32 s37, s37, 28672
    buffer_load_dword v25, v13, s[76:79], s37 offen
    s_mul_i32 s36, s40, 7
    s_add_u32 s36, s36, 6
    s_lshr_b32 s37, s36, 1
    s_lshl_b32 s37, s37, 2
    s_and_b32 s36, s36, 1
    s_add_u32 s37, s37, s36
    s_add_u32 s37, s37, 0
    s_mul_i32 s37, s37, 28672
    buffer_load_dword v26, v13, s[76:79], s37 offen
    s_mul_i32 s36, s40, 7
    s_add_u32 s36, s36, 0
    s_lshr_b32 s37, s36, 1
    s_lshl_b32 s37, s37, 2
    s_and_b32 s36, s36, 1
    s_add_u32 s37, s37, s36
    s_add_u32 s37, s37, 2
    s_mul_i32 s37, s37, 28672
    buffer_load_dword v27, v13, s[76:79], s37 offen
    s_mul_i32 s36, s40, 7
    s_add_u32 s36, s36, 1
    s_lshr_b32 s37, s36, 1
    s_lshl_b32 s37, s37, 2
    s_and_b32 s36, s36, 1
    s_add_u32 s37, s37, s36
    s_add_u32 s37, s37, 2
    s_mul_i32 s37, s37, 28672
    buffer_load_dword v28, v13, s[76:79], s37 offen
    s_mul_i32 s36, s40, 7
    s_add_u32 s36, s36, 2
    s_lshr_b32 s37, s36, 1
    s_lshl_b32 s37, s37, 2
    s_and_b32 s36, s36, 1
    s_add_u32 s37, s37, s36
    s_add_u32 s37, s37, 2
    s_mul_i32 s37, s37, 28672
    buffer_load_dword v29, v13, s[76:79], s37 offen
    s_mul_i32 s36, s40, 7
    s_add_u32 s36, s36, 3
    s_lshr_b32 s37, s36, 1
    s_lshl_b32 s37, s37, 2
    s_and_b32 s36, s36, 1
    s_add_u32 s37, s37, s36
    s_add_u32 s37, s37, 2
    s_mul_i32 s37, s37, 28672
    buffer_load_dword v30, v13, s[76:79], s37 offen
    s_mul_i32 s36, s40, 7
    s_add_u32 s36, s36, 4
    s_lshr_b32 s37, s36, 1
    s_lshl_b32 s37, s37, 2
    s_and_b32 s36, s36, 1
    s_add_u32 s37, s37, s36
    s_add_u32 s37, s37, 2
    s_mul_i32 s37, s37, 28672
    buffer_load_dword v31, v13, s[76:79], s37 offen
    s_mul_i32 s36, s40, 7
    s_add_u32 s36, s36, 5
    s_lshr_b32 s37, s36, 1
    s_lshl_b32 s37, s37, 2
    s_and_b32 s36, s36, 1
    s_add_u32 s37, s37, s36
    s_add_u32 s37, s37, 2
    s_mul_i32 s37, s37, 28672
    buffer_load_dword v32, v13, s[76:79], s37 offen
    s_mul_i32 s36, s40, 7
    s_add_u32 s36, s36, 6
    s_lshr_b32 s37, s36, 1
    s_lshl_b32 s37, s37, 2
    s_and_b32 s36, s36, 1
    s_add_u32 s37, s37, s36
    s_add_u32 s37, s37, 2
    s_mul_i32 s37, s37, 28672
    buffer_load_dword v33, v13, s[76:79], s37 offen
K_tail:
K_done:
    s_endpgm
.fill 256, 4, 0xbf800000
.section .rodata,"a"
.p2align 6
.amdhsa_kernel sequential_preLN__sliding_local_dilated__dense_activation_relu__prompt_kernel
  .amdhsa_next_free_vgpr 512
  .amdhsa_next_free_sgpr 102
  .amdhsa_accum_offset 256
  .amdhsa_group_segment_fixed_size 0
  .amdhsa_kernarg_size 72
  .amdhsa_user_sgpr_count 2
  .amdhsa_user_sgpr_kernarg_segment_ptr 1
  .amdhsa_system_sgpr_workgroup_id_x 1
.end_amdhsa_kernel
```
